```python
import torch

def _softmax(x, axis=-1):
    return torch.softmax(x, dim=axis)
def _gelu(x):
    return torch.nn.functional.gelu(x, approximate="tanh")
def _silu(x):
    return torch.nn.functional.silu(x)
def _sigmoid(x):
    return torch.sigmoid(x)
def _layernorm(x, axis=-1, eps=1e-5):
    m = x.mean(dim=axis, keepdim=True)
    v = x.var(dim=axis, keepdim=True, unbiased=False)
    return (x - m) / torch.sqrt(v + eps)
def _scatter_add(tgt, idx, src, axis=0):
    return tgt.clone().index_add_(axis, idx, src)
def _segment_sum(src, seg, n):
    out = torch.zeros((n,) + src.shape[1:], dtype=src.dtype)
    return out.index_add_(0, seg, src)
def _pad(x, pw):
    flat = tuple(v for pair in reversed(pw) for v in pair)
    return torch.nn.functional.pad(x, flat)

kernel_name = 'parallel_sum__sliding_block__dense_activation_relu__prompt'

def setup_inputs():

    _w = (lambda a: (lambda t: t.to(torch.bfloat16) if t.is_floating_point() else t)(torch.as_tensor(a)))
    def _A_setup():
        B, S, D = 1, 2048, 512
        return {
            "x": _w((lambda *s: torch.randn(*s, dtype=torch.bfloat16) * 0.05)(B, S, D)),
            "wqkv": _w((lambda *s: torch.randn(*s, dtype=torch.bfloat16) * 0.05)(D, 3 * D)),
            "wo": _w((lambda *s: torch.randn(*s, dtype=torch.bfloat16) * 0.05)(D, D)),
        }
    _A_in = _A_setup()

    def _B_setup():
        B, S, D, Dff = 1, 2048, 512, 1376
        return {
            "x": _w((lambda *s: torch.randn(*s, dtype=torch.bfloat16) * 0.05)(B, S, D)),
            "w1": _w((lambda *s: torch.randn(*s, dtype=torch.bfloat16) * 0.05)(D, Dff)),
            "w2": _w((lambda *s: torch.randn(*s, dtype=torch.bfloat16) * 0.05)(Dff, D)),
        }
    _B_in = _B_setup()

    return {
        "A_x": _A_in["x"],
        "A_wqkv": _A_in["wqkv"],
        "A_wo": _A_in["wo"],
        "B_x": _B_in["x"],
        "B_w1": _B_in["w1"],
        "B_w2": _B_in["w2"],
    }

def reference(A_x, A_wqkv, A_wo, B_x, B_w1, B_w2):
    def _A_ref(x, wqkv, wo):
        B, S, D = x.shape
        H = 32; Dh = D // H; W = 256
        qkv = (lambda x, *d: x.permute(*d))((x @ wqkv).reshape(B, S, 3, H, Dh), 2, 0, 3, 1, 4)
        q, k, v = qkv[0], qkv[1], qkv[2]
        scores = torch.einsum("bhqd,bhkd->bhqk", q, k) * (Dh ** -0.5)
        idx = torch.arange(S)
        mask = (idx[:, None] - idx[None, :] >= 0) & (idx[:, None] - idx[None, :] < W)
        scores = torch.where(mask[None, None], scores, -1e9)
        p = _softmax(scores, axis=-1)
        o = torch.einsum("bhqk,bhkd->bhqd", p, v)
        return (lambda x, *d: x.permute(*d))(o, 0, 2, 1, 3).reshape(B, S, D) @ wo

    def _B_ref(x, w1, w2):
        h = torch.einsum("bsd,df->bsf", x, w1)
        zero = torch.zeros_like(h)
        h = torch.maximum(h, zero)
        return torch.einsum("bsf,fd->bsd", h, w2)

    x = A_x
    xn = _layernorm(x, axis=-1)
    return x + _A_ref(xn, A_wqkv, A_wo) + _B_ref(xn, B_w1, B_w2)
```

```asm
; @launch grid=(256,1,1) block=(512,1,1) lds=163840
.amdgcn_target "amdgcn-amd-amdhsa--gfx950"
.text
.globl parallel_sum__sliding_block__dense_activation_relu__prompt_kernel
.p2align 8
.type parallel_sum__sliding_block__dense_activation_relu__prompt_kernel,@function
parallel_sum__sliding_block__dense_activation_relu__prompt_kernel:
Lpf_first:
s_cmp_ge_u32 s2, 256
s_cbranch_scc1 parallel_sum__sliding_block__dense_activation_relu__prompt_kernel_end
s_load_dwordx16 s[60:75], s[0:1], 0
s_load_dwordx2 s[76:77], s[0:1], 64
s_memtime s[78:79]
v_and_b32 v1, 63, v0
v_lshrrev_b32 v2, 6, v0
s_and_b32 s32, s2, 7
s_lshr_b32 s33, s2, 3
v_readfirstlane_b32 s20, v2
v_lshlrev_b32 v8, 4, v1
s_and_b32 s21, s32, 1
s_lshl_b32 s21, s21, 3
s_and_b32 s34, s33, 7
s_add_u32 s21, s21, s34
s_lshr_b32 s22, s32, 1
s_lshl_b32 s22, s22, 2
s_lshr_b32 s34, s33, 3
s_add_u32 s22, s22, s34
s_and_b32 s38, s20, 3
s_lshl_b32 s39, s21, 2
s_add_u32 s39, s39, s38
s_cmp_ge_u32 s20, 4
s_cbranch_scc1 Lloader
v_lshrrev_b32 v2, 5, v1
v_bfe_u32 v3, v1, 2, 2
v_lshl_add_u32 v3, v2, 3, v3
v_mul_u32_u24 v3, 192, v3
v_bfe_u32 v4, v1, 4, 1
v_lshlrev_b32 v4, 5, v4
v_and_b32 v5, 3, v1
v_lshl_add_u32 v4, v5, 3, v4
v_add_u32 v3, v3, v4
v_and_b32 v4, 31, v1
v_bfe_u32 v5, v1, 1, 3
v_xor_b32 v5, v5, v2
v_lshlrev_b32 v5, 4, v5
s_lshl_b32 s28, s38, 12
s_add_u32 s28, s28, 73728
v_lshlrev_b32 v6, 7, v4
v_add_u32 v6, s28, v6
s_add_u32 s34, s38, 0
s_and_b32 s34, s34, 3
s_mul_i32 s35, s34, 3072
v_add_u32 v9, s35, v3
s_lshl_b32 s35, s34, 5
v_xor_b32 v7, s35, v5
v_add_u32 v13, v6, v7
s_add_u32 s34, s38, 1
s_and_b32 s34, s34, 3
s_mul_i32 s35, s34, 3072
v_add_u32 v10, s35, v3
s_lshl_b32 s35, s34, 5
v_xor_b32 v7, s35, v5
v_add_u32 v14, v6, v7
s_add_u32 s34, s38, 2
s_and_b32 s34, s34, 3
s_mul_i32 s35, s34, 3072
v_add_u32 v11, s35, v3
s_lshl_b32 s35, s34, 5
v_xor_b32 v7, s35, v5
v_add_u32 v15, v6, v7
s_add_u32 s34, s38, 3
s_and_b32 s34, s34, 3
s_mul_i32 s35, s34, 3072
v_add_u32 v12, s35, v3
s_lshl_b32 s35, s34, 5
v_xor_b32 v7, s35, v5
v_add_u32 v16, v6, v7
v_and_b32 v3, 3, v1
v_bfe_u32 v6, v1, 2, 1
v_bfe_u32 v5, v1, 4, 1
v_xor_b32 v6, v6, v5
v_or_b32 v3, v3, v6
v_cmp_eq_u32 vcc, 0, v3
v_mov_b32 v5, 0x3f803f80
s_nop 0
v_cndmask_b32 v32, 0, v5, vcc
v_mov_b32 v33, v32
v_mov_b32 v34, v32
v_mov_b32 v35, v32
s_mul_i32 s34, s38, 384
s_add_u32 s35, s34, 159232
v_lshl_add_u32 v17, v4, 2, s35
v_lshlrev_b32 v18, 2, v1
v_add_u32 v18, 159232, v18
s_add_u32 s35, s34, 160768
v_lshl_add_u32 v19, v1, 2, s35
v_lshlrev_b32 v2, 4, v2
v_add_u32 v20, s35, v2
v_lshl_add_u32 v24, v4, 5, v2
s_lshl_b32 s30, s21, 7
s_lshl_b32 s34, s22, 3
s_add_u32 s30, s30, s34
s_lshl_b32 s34, s38, 1
s_add_u32 s30, s30, s34
s_lshl_b32 s31, s30, 10
s_or_b32 s34, s2, s20
v_or_b32 v2, s34, v1
v_mov_b32 v3, 0x7ffffff0
v_mov_b32 v4, 0
v_cmp_eq_u32 vcc, 0, v2
s_nop 0
s_waitcnt lgkmcnt(0)
v_cndmask_b32 v7, v3, v4, vcc
s_mov_b32 s4, s60
s_and_b32 s5, s61, 0xffff
s_mov_b32 s6, 2097152
s_mov_b32 s7, 0x20000
buffer_load_dwordx4 v[72:75], v8, s[4:7], s31 offen
buffer_load_dwordx4 v[76:79], v8, s[4:7], s31 offen offset:1024
s_mov_b32 s8, s62
s_and_b32 s9, s63, 0xffff
s_mov_b32 s10, 1572864
s_mov_b32 s11, 0x20000
s_lshl_b32 s51, s2, 2
s_add_u32 s51, s51, s38
s_mul_i32 s50, s51, 1536
buffer_load_dwordx4 v[120:123], v8, s[8:11], s50 offen
buffer_load_dwordx4 v[120:123], v8, s[8:11], s50 offen offset:512
s_mov_b32 s12, s68
s_and_b32 s13, s69, 0xffff
s_mov_b32 s14, 1409024
s_mov_b32 s15, 0x20000
s_lshl_b32 s51, s2, 2
s_add_u32 s51, s51, s38
s_mul_i32 s50, s51, 1376
buffer_load_dwordx4 v[120:123], v8, s[12:15], s50 offen
buffer_load_dwordx4 v[120:123], v8, s[12:15], s50 offen offset:352
s_mov_b32 s88, s74
s_and_b32 s89, s75, 0xffff
s_mov_b32 s90, 256
s_mov_b32 s91, 0x20000
s_or_b32 s78, s78, 1
v_mov_b32 v5, s78
buffer_store_dword v5, v7, s[88:91], 0 offen sc0 sc1
v_mov_b32 v7, 0
s_mov_b32 s16, s76
s_and_b32 s17, s77, 0xffff
s_mov_b32 s18, 16777216
s_mov_b32 s19, 0x20000
s_mul_i32 s34, s22, 3
s_add_u32 s34, s34, 0
s_lshr_b32 s35, s34, 4
s_and_b32 s34, s34, 15
s_lshl_b32 s34, s34, 17
s_lshl_b32 s40, s35, 21
s_add_u32 s40, s40, s34
s_lshl_b32 s34, s39, 10
s_add_u32 s40, s40, s34
s_cmp_eq_u32 s35, 0
s_cselect_b32 s44, 1052289595, 1.0
s_cmp_eq_u32 s35, 2
s_cselect_b64 vcc, -1, 0
v_cndmask_b32 v21, v8, v24, vcc
s_mul_i32 s34, s22, 3
s_add_u32 s34, s34, 1
s_lshr_b32 s35, s34, 4
s_and_b32 s34, s34, 15
s_lshl_b32 s34, s34, 17
s_lshl_b32 s41, s35, 21
s_add_u32 s41, s41, s34
s_lshl_b32 s34, s39, 10
s_add_u32 s41, s41, s34
s_cmp_eq_u32 s35, 0
s_cselect_b32 s45, 1052289595, 1.0
s_cmp_eq_u32 s35, 2
s_cselect_b64 vcc, -1, 0
v_cndmask_b32 v22, v8, v24, vcc
s_mul_i32 s34, s22, 3
s_add_u32 s34, s34, 2
s_lshr_b32 s35, s34, 4
s_and_b32 s34, s34, 15
s_lshl_b32 s34, s34, 17
s_lshl_b32 s42, s35, 21
s_add_u32 s42, s42, s34
s_lshl_b32 s34, s39, 10
s_add_u32 s42, s42, s34
s_cmp_eq_u32 s35, 0
s_cselect_b32 s46, 1052289595, 1.0
s_cmp_eq_u32 s35, 2
s_cselect_b64 vcc, -1, 0
v_cndmask_b32 v23, v8, v24, vcc
s_mul_i32 s43, s39, 86
s_mul_i32 s34, s22, 6
s_add_u32 s43, s43, s34
s_lshl_b32 s43, s43, 10
s_add_u32 s43, s43, 6291456
s_lshl_b32 s52, s32, 2
s_and_b32 s34, s33, 3
s_add_u32 s52, s52, s34
s_lshr_b32 s53, s33, 2
s_lshl_b32 s80, s32, 2
s_lshr_b32 s34, s33, 3
s_add_u32 s80, s80, s34
s_and_b32 s81, s33, 7
s_and_b32 s82, s20, 1
s_lshr_b32 s83, s20, 1
s_lshl_b32 s84, s80, 1
s_add_u32 s84, s84, s82
s_mul_i32 s85, s84, 86
s_mul_i32 s34, s83, 22
s_add_u32 s85, s85, s34
s_lshl_b32 s85, s85, 10
s_add_u32 s85, s85, 6291456
s_lshl_b32 s86, s84, 5
s_lshl_b32 s34, s83, 3
s_add_u32 s86, s86, s34
s_lshl_b32 s86, s86, 10
s_add_u32 s86, s86, 12582912
s_mul_i32 s87, s83, 22
s_add_u32 s87, s87, s82
s_lshl_b32 s87, s87, 14
s_lshl_b32 s34, s81, 7
s_add_u32 s87, s87, s34
s_lshl_b32 s96, s83, 3
s_add_u32 s96, s96, s82
s_lshl_b32 s96, s96, 14
s_lshl_b32 s34, s81, 7
s_add_u32 s96, s96, s34
s_lshl_b32 s97, s20, 11
s_lshl_b32 s34, s53, 3
s_add_u32 s99, s34, s20
s_mov_b32 s100, s52
s_mov_b32 s101, s53
s_mov_b32 s8, s70
s_and_b32 s9, s71, 0xffff
s_mov_b32 s10, 1409024
s_mov_b32 s11, 0x20000
s_mov_b32 s12, s64
s_and_b32 s13, s65, 0xffff
s_mov_b32 s14, 524288
s_mov_b32 s15, 0x20000
s_waitcnt vmcnt(5)
v_lshlrev_b32 v96, 16, v72
v_and_b32 v97, 0xffff0000, v72
v_lshlrev_b32 v98, 16, v73
v_and_b32 v99, 0xffff0000, v73
v_lshlrev_b32 v100, 16, v74
v_and_b32 v101, 0xffff0000, v74
v_lshlrev_b32 v102, 16, v75
v_and_b32 v103, 0xffff0000, v75
v_lshlrev_b32 v104, 16, v76
v_and_b32 v105, 0xffff0000, v76
v_lshlrev_b32 v106, 16, v77
v_and_b32 v107, 0xffff0000, v77
v_lshlrev_b32 v108, 16, v78
v_and_b32 v109, 0xffff0000, v78
v_lshlrev_b32 v110, 16, v79
v_and_b32 v111, 0xffff0000, v79
v_add_f32 v88, v96, v97
v_mul_f32 v89, v96, v96
v_add_f32 v90, v104, v105
v_mul_f32 v91, v104, v104
v_fma_f32 v89, v97, v97, v89
v_fma_f32 v91, v105, v105, v91
v_add_f32 v88, v88, v98
v_fma_f32 v89, v98, v98, v89
v_add_f32 v90, v90, v106
v_fma_f32 v91, v106, v106, v91
v_add_f32 v88, v88, v99
v_fma_f32 v89, v99, v99, v89
v_add_f32 v90, v90, v107
v_fma_f32 v91, v107, v107, v91
v_add_f32 v88, v88, v100
v_fma_f32 v89, v100, v100, v89
v_add_f32 v90, v90, v108
v_fma_f32 v91, v108, v108, v91
v_add_f32 v88, v88, v101
v_fma_f32 v89, v101, v101, v89
v_add_f32 v90, v90, v109
v_fma_f32 v91, v109, v109, v91
v_add_f32 v88, v88, v102
v_fma_f32 v89, v102, v102, v89
v_add_f32 v90, v90, v110
v_fma_f32 v91, v110, v110, v91
v_add_f32 v88, v88, v103
v_fma_f32 v89, v103, v103, v89
v_add_f32 v90, v90, v111
v_fma_f32 v91, v111, v111, v91
s_nop 0
v_add_f32_dpp v88, v88, v88 row_shr:1 row_mask:0xf bank_mask:0xf bound_ctrl:0
v_add_f32_dpp v89, v89, v89 row_shr:1 row_mask:0xf bank_mask:0xf bound_ctrl:0
v_add_f32_dpp v90, v90, v90 row_shr:1 row_mask:0xf bank_mask:0xf bound_ctrl:0
v_add_f32_dpp v91, v91, v91 row_shr:1 row_mask:0xf bank_mask:0xf bound_ctrl:0
v_add_f32_dpp v88, v88, v88 row_shr:2 row_mask:0xf bank_mask:0xf bound_ctrl:0
v_add_f32_dpp v89, v89, v89 row_shr:2 row_mask:0xf bank_mask:0xf bound_ctrl:0
v_add_f32_dpp v90, v90, v90 row_shr:2 row_mask:0xf bank_mask:0xf bound_ctrl:0
v_add_f32_dpp v91, v91, v91 row_shr:2 row_mask:0xf bank_mask:0xf bound_ctrl:0
v_add_f32_dpp v88, v88, v88 row_shr:4 row_mask:0xf bank_mask:0xf bound_ctrl:0
v_add_f32_dpp v89, v89, v89 row_shr:4 row_mask:0xf bank_mask:0xf bound_ctrl:0
v_add_f32_dpp v90, v90, v90 row_shr:4 row_mask:0xf bank_mask:0xf bound_ctrl:0
v_add_f32_dpp v91, v91, v91 row_shr:4 row_mask:0xf bank_mask:0xf bound_ctrl:0
v_add_f32_dpp v88, v88, v88 row_shr:8 row_mask:0xf bank_mask:0xf bound_ctrl:0
v_add_f32_dpp v89, v89, v89 row_shr:8 row_mask:0xf bank_mask:0xf bound_ctrl:0
v_add_f32_dpp v90, v90, v90 row_shr:8 row_mask:0xf bank_mask:0xf bound_ctrl:0
v_add_f32_dpp v91, v91, v91 row_shr:8 row_mask:0xf bank_mask:0xf bound_ctrl:0
v_add_f32_dpp v88, v88, v88 row_bcast:15 row_mask:0xa bank_mask:0xf
v_add_f32_dpp v89, v89, v89 row_bcast:15 row_mask:0xa bank_mask:0xf
v_add_f32_dpp v90, v90, v90 row_bcast:15 row_mask:0xa bank_mask:0xf
v_add_f32_dpp v91, v91, v91 row_bcast:15 row_mask:0xa bank_mask:0xf
v_add_f32_dpp v88, v88, v88 row_bcast:31 row_mask:0xc bank_mask:0xf
v_add_f32_dpp v89, v89, v89 row_bcast:31 row_mask:0xc bank_mask:0xf
v_add_f32_dpp v90, v90, v90 row_bcast:31 row_mask:0xc bank_mask:0xf
v_add_f32_dpp v91, v91, v91 row_bcast:31 row_mask:0xc bank_mask:0xf
v_mul_f32 v88, 0x3b000000, v88
v_mul_f32 v89, 0x3b000000, v89
v_fma_f32 v89, -v88, v88, v89
v_max_f32 v89, 0, v89
v_cvt_pk_bf16_f32 v88, v88, v88
v_cvt_pk_bf16_f32 v89, v89, v89
v_and_b32 v89, 0xffff0000, v89
v_add_f32 v89, 0x3727c5ac, v89
v_cvt_pk_bf16_f32 v89, v89, v89
v_and_b32 v89, 0xffff0000, v89
v_sqrt_f32 v89, v89
v_and_b32 v88, 0xffff, v88
v_cvt_pk_bf16_f32 v89, v89, v89
v_and_b32 v89, 0xffff0000, v89
v_or_b32 v124, v88, v89
v_mul_f32 v90, 0x3b000000, v90
v_mul_f32 v91, 0x3b000000, v91
v_fma_f32 v91, -v90, v90, v91
v_max_f32 v91, 0, v91
v_cvt_pk_bf16_f32 v90, v90, v90
v_cvt_pk_bf16_f32 v91, v91, v91
v_and_b32 v91, 0xffff0000, v91
v_add_f32 v91, 0x3727c5ac, v91
v_cvt_pk_bf16_f32 v91, v91, v91
v_and_b32 v91, 0xffff0000, v91
v_sqrt_f32 v91, v91
v_and_b32 v90, 0xffff, v90
v_cvt_pk_bf16_f32 v91, v91, v91
v_and_b32 v91, 0xffff0000, v91
v_or_b32 v126, v90, v91
buffer_load_dword v6, v7, s[88:91], 0 offen sc0 sc1
s_barrier
ds_read_b128 a[0:3], v13 offset:0
ds_read_b64_tr_b16 v[48:49], v9 offset:0
ds_read_b64_tr_b16 v[50:51], v9 offset:768
ds_read_b64_tr_b16 v[52:53], v9 offset:64
ds_read_b64_tr_b16 v[54:55], v9 offset:832
ds_read_b64_tr_b16 v[56:57], v9 offset:128
ds_read_b64_tr_b16 v[58:59], v9 offset:896
s_waitcnt lgkmcnt(4)
v_mfma_f32_32x32x16_bf16 v[72:87], v[48:51], a[0:3], 0
ds_read_b128 a[4:7], v14 offset:0
ds_read_b64_tr_b16 v[60:61], v10 offset:0
ds_read_b64_tr_b16 v[62:63], v10 offset:768
v_mfma_f32_16x16x32_bf16 v[36:39], v[32:35], v[48:51], 0
s_waitcnt lgkmcnt(5)
v_mfma_f32_32x32x16_bf16 v[88:103], v[52:55], a[0:3], 0
ds_read_b64_tr_b16 v[64:65], v10 offset:64
ds_read_b64_tr_b16 v[66:67], v10 offset:832
v_mfma_f32_16x16x32_bf16 v[40:43], v[32:35], v[52:55], 0
s_waitcnt lgkmcnt(5)
v_mfma_f32_32x32x16_bf16 v[104:119], v[56:59], a[0:3], 0
ds_read_b64_tr_b16 v[68:69], v10 offset:128
ds_read_b64_tr_b16 v[70:71], v10 offset:896
v_mfma_f32_16x16x32_bf16 v[44:47], v[32:35], v[56:59], 0
s_waitcnt lgkmcnt(4)
v_mfma_f32_32x32x16_bf16 v[72:87], v[60:63], a[4:7], v[72:87]
ds_read_b128 a[8:11], v15 offset:0
ds_read_b64_tr_b16 v[48:49], v11 offset:0
ds_read_b64_tr_b16 v[50:51], v11 offset:768
s_waitcnt lgkmcnt(5)
v_mfma_f32_32x32x16_bf16 v[88:103], v[64:67], a[4:7], v[88:103]
ds_read_b64_tr_b16 v[52:53], v11 offset:64
ds_read_b64_tr_b16 v[54:55], v11 offset:832
s_waitcnt lgkmcnt(5)
v_mfma_f32_32x32x16_bf16 v[104:119], v[68:71], a[4:7], v[104:119]
ds_read_b64_tr_b16 v[56:57], v11 offset:128
ds_read_b64_tr_b16 v[58:59], v11 offset:896
s_waitcnt lgkmcnt(4)
v_mfma_f32_32x32x16_bf16 v[72:87], v[48:51], a[8:11], v[72:87]
ds_read_b128 a[12:15], v16 offset:0
ds_read_b64_tr_b16 v[60:61], v12 offset:0
ds_read_b64_tr_b16 v[62:63], v12 offset:768
s_waitcnt lgkmcnt(5)
v_mfma_f32_32x32x16_bf16 v[88:103], v[52:55], a[8:11], v[88:103]
ds_read_b64_tr_b16 v[64:65], v12 offset:64
ds_read_b64_tr_b16 v[66:67], v12 offset:832
s_waitcnt lgkmcnt(5)
v_mfma_f32_32x32x16_bf16 v[104:119], v[56:59], a[8:11], v[104:119]
ds_read_b64_tr_b16 v[68:69], v12 offset:128
ds_read_b64_tr_b16 v[70:71], v12 offset:896
s_waitcnt vmcnt(0)
v_readfirstlane_b32 s23, v6
s_nop 3
s_cmp_eq_u32 s23, 0
s_cbranch_scc1 Ln_6_stub
Ln_6:
v_mov_b32 v125, s23
v_mov_b32 v127, s23
v_cmp_eq_u32 vcc, 63, v1
v_mov_b32 v2, 0x7ffffff0
v_mov_b32 v3, 0
v_cndmask_b32 v2, v2, v3, vcc
s_lshl_b32 s34, s30, 3
s_add_u32 s34, s34, 15761408
buffer_store_dwordx4 v[124:127], v2, s[16:19], s34 offen sc1
s_barrier
s_waitcnt lgkmcnt(4)
v_mfma_f32_32x32x16_bf16 v[72:87], v[60:63], a[12:15], v[72:87]
ds_read_b128 a[16:19], v13 offset:16384
ds_read_b64_tr_b16 v[48:49], v9 offset:12288
ds_read_b64_tr_b16 v[50:51], v9 offset:13056
s_waitcnt lgkmcnt(5)
v_mfma_f32_32x32x16_bf16 v[88:103], v[64:67], a[12:15], v[88:103]
ds_read_b64_tr_b16 v[52:53], v9 offset:12352
ds_read_b64_tr_b16 v[54:55], v9 offset:13120
s_waitcnt lgkmcnt(5)
v_mfma_f32_32x32x16_bf16 v[104:119], v[68:71], a[12:15], v[104:119]
ds_read_b64_tr_b16 v[56:57], v9 offset:12416
ds_read_b64_tr_b16 v[58:59], v9 offset:13184
s_waitcnt lgkmcnt(4)
v_mfma_f32_32x32x16_bf16 v[72:87], v[48:51], a[16:19], v[72:87]
ds_read_b128 a[20:23], v14 offset:16384
ds_read_b64_tr_b16 v[60:61], v10 offset:12288
ds_read_b64_tr_b16 v[62:63], v10 offset:13056
v_mfma_f32_16x16x32_bf16 v[36:39], v[32:35], v[48:51], v[36:39]
s_waitcnt lgkmcnt(5)
v_mfma_f32_32x32x16_bf16 v[88:103], v[52:55], a[16:19], v[88:103]
ds_read_b64_tr_b16 v[64:65], v10 offset:12352
ds_read_b64_tr_b16 v[66:67], v10 offset:13120
v_mfma_f32_16x16x32_bf16 v[40:43], v[32:35], v[52:55], v[40:43]
s_waitcnt lgkmcnt(5)
v_mfma_f32_32x32x16_bf16 v[104:119], v[56:59], a[16:19], v[104:119]
ds_read_b64_tr_b16 v[68:69], v10 offset:12416
ds_read_b64_tr_b16 v[70:71], v10 offset:13184
v_mfma_f32_16x16x32_bf16 v[44:47], v[32:35], v[56:59], v[44:47]
s_waitcnt lgkmcnt(4)
v_mfma_f32_32x32x16_bf16 v[72:87], v[60:63], a[20:23], v[72:87]
ds_read_b128 a[24:27], v15 offset:16384
ds_read_b64_tr_b16 v[48:49], v11 offset:12288
ds_read_b64_tr_b16 v[50:51], v11 offset:13056
s_waitcnt lgkmcnt(5)
v_mfma_f32_32x32x16_bf16 v[88:103], v[64:67], a[20:23], v[88:103]
ds_read_b64_tr_b16 v[52:53], v11 offset:12352
ds_read_b64_tr_b16 v[54:55], v11 offset:13120
s_waitcnt lgkmcnt(5)
v_mfma_f32_32x32x16_bf16 v[104:119], v[68:71], a[20:23], v[104:119]
ds_read_b64_tr_b16 v[56:57], v11 offset:12416
ds_read_b64_tr_b16 v[58:59], v11 offset:13184
s_waitcnt lgkmcnt(4)
v_mfma_f32_32x32x16_bf16 v[72:87], v[48:51], a[24:27], v[72:87]
ds_read_b128 a[28:31], v16 offset:16384
ds_read_b64_tr_b16 v[60:61], v12 offset:12288
ds_read_b64_tr_b16 v[62:63], v12 offset:13056
s_waitcnt lgkmcnt(5)
v_mfma_f32_32x32x16_bf16 v[88:103], v[52:55], a[24:27], v[88:103]
ds_read_b64_tr_b16 v[64:65], v12 offset:12352
ds_read_b64_tr_b16 v[66:67], v12 offset:13120
s_waitcnt lgkmcnt(5)
v_mfma_f32_32x32x16_bf16 v[104:119], v[56:59], a[24:27], v[104:119]
ds_read_b64_tr_b16 v[68:69], v12 offset:12416
ds_read_b64_tr_b16 v[70:71], v12 offset:13184
s_barrier
s_waitcnt lgkmcnt(4)
v_mfma_f32_32x32x16_bf16 v[72:87], v[60:63], a[28:31], v[72:87]
ds_read_b128 a[32:35], v13 offset:32768
ds_read_b64_tr_b16 v[48:49], v9 offset:24576
ds_read_b64_tr_b16 v[50:51], v9 offset:25344
s_waitcnt lgkmcnt(5)
v_mfma_f32_32x32x16_bf16 v[88:103], v[64:67], a[28:31], v[88:103]
ds_read_b64_tr_b16 v[52:53], v9 offset:24640
ds_read_b64_tr_b16 v[54:55], v9 offset:25408
s_waitcnt lgkmcnt(5)
v_mfma_f32_32x32x16_bf16 v[104:119], v[68:71], a[28:31], v[104:119]
ds_read_b64_tr_b16 v[56:57], v9 offset:24704
ds_read_b64_tr_b16 v[58:59], v9 offset:25472
s_waitcnt lgkmcnt(4)
v_mfma_f32_32x32x16_bf16 v[72:87], v[48:51], a[32:35], v[72:87]
ds_read_b128 a[36:39], v14 offset:32768
ds_read_b64_tr_b16 v[60:61], v10 offset:24576
ds_read_b64_tr_b16 v[62:63], v10 offset:25344
v_mfma_f32_16x16x32_bf16 v[36:39], v[32:35], v[48:51], v[36:39]
s_waitcnt lgkmcnt(5)
v_mfma_f32_32x32x16_bf16 v[88:103], v[52:55], a[32:35], v[88:103]
ds_read_b64_tr_b16 v[64:65], v10 offset:24640
ds_read_b64_tr_b16 v[66:67], v10 offset:25408
v_mfma_f32_16x16x32_bf16 v[40:43], v[32:35], v[52:55], v[40:43]
s_waitcnt lgkmcnt(5)
v_mfma_f32_32x32x16_bf16 v[104:119], v[56:59], a[32:35], v[104:119]
ds_read_b64_tr_b16 v[68:69], v10 offset:24704
ds_read_b64_tr_b16 v[70:71], v10 offset:25472
v_mfma_f32_16x16x32_bf16 v[44:47], v[32:35], v[56:59], v[44:47]
s_waitcnt lgkmcnt(4)
v_mfma_f32_32x32x16_bf16 v[72:87], v[60:63], a[36:39], v[72:87]
ds_read_b128 a[40:43], v15 offset:32768
ds_read_b64_tr_b16 v[48:49], v11 offset:24576
ds_read_b64_tr_b16 v[50:51], v11 offset:25344
s_waitcnt lgkmcnt(5)
v_mfma_f32_32x32x16_bf16 v[88:103], v[64:67], a[36:39], v[88:103]
ds_read_b64_tr_b16 v[52:53], v11 offset:24640
ds_read_b64_tr_b16 v[54:55], v11 offset:25408
s_waitcnt lgkmcnt(5)
v_mfma_f32_32x32x16_bf16 v[104:119], v[68:71], a[36:39], v[104:119]
ds_read_b64_tr_b16 v[56:57], v11 offset:24704
ds_read_b64_tr_b16 v[58:59], v11 offset:25472
s_waitcnt lgkmcnt(4)
v_mfma_f32_32x32x16_bf16 v[72:87], v[48:51], a[40:43], v[72:87]
ds_read_b128 a[44:47], v16 offset:32768
ds_read_b64_tr_b16 v[60:61], v12 offset:24576
ds_read_b64_tr_b16 v[62:63], v12 offset:25344
s_waitcnt lgkmcnt(5)
v_mfma_f32_32x32x16_bf16 v[88:103], v[52:55], a[40:43], v[88:103]
ds_read_b64_tr_b16 v[64:65], v12 offset:24640
ds_read_b64_tr_b16 v[66:67], v12 offset:25408
s_waitcnt lgkmcnt(5)
v_mfma_f32_32x32x16_bf16 v[104:119], v[56:59], a[40:43], v[104:119]
ds_read_b64_tr_b16 v[68:69], v12 offset:24704
ds_read_b64_tr_b16 v[70:71], v12 offset:25472
s_barrier
s_waitcnt lgkmcnt(4)
v_mfma_f32_32x32x16_bf16 v[72:87], v[60:63], a[44:47], v[72:87]
ds_read_b128 a[48:51], v13 offset:49152
ds_read_b64_tr_b16 v[48:49], v9 offset:36864
ds_read_b64_tr_b16 v[50:51], v9 offset:37632
s_waitcnt lgkmcnt(5)
v_mfma_f32_32x32x16_bf16 v[88:103], v[64:67], a[44:47], v[88:103]
ds_read_b64_tr_b16 v[52:53], v9 offset:36928
ds_read_b64_tr_b16 v[54:55], v9 offset:37696
s_waitcnt lgkmcnt(5)
v_mfma_f32_32x32x16_bf16 v[104:119], v[68:71], a[44:47], v[104:119]
ds_read_b64_tr_b16 v[56:57], v9 offset:36992
ds_read_b64_tr_b16 v[58:59], v9 offset:37760
s_waitcnt lgkmcnt(4)
v_mfma_f32_32x32x16_bf16 v[72:87], v[48:51], a[48:51], v[72:87]
ds_read_b128 a[52:55], v14 offset:49152
ds_read_b64_tr_b16 v[60:61], v10 offset:36864
ds_read_b64_tr_b16 v[62:63], v10 offset:37632
v_mfma_f32_16x16x32_bf16 v[36:39], v[32:35], v[48:51], v[36:39]
s_waitcnt lgkmcnt(5)
v_mfma_f32_32x32x16_bf16 v[88:103], v[52:55], a[48:51], v[88:103]
ds_read_b64_tr_b16 v[64:65], v10 offset:36928
ds_read_b64_tr_b16 v[66:67], v10 offset:37696
v_mfma_f32_16x16x32_bf16 v[40:43], v[32:35], v[52:55], v[40:43]
s_waitcnt lgkmcnt(5)
v_mfma_f32_32x32x16_bf16 v[104:119], v[56:59], a[48:51], v[104:119]
ds_read_b64_tr_b16 v[68:69], v10 offset:36992
ds_read_b64_tr_b16 v[70:71], v10 offset:37760
v_mfma_f32_16x16x32_bf16 v[44:47], v[32:35], v[56:59], v[44:47]
s_waitcnt lgkmcnt(4)
v_mfma_f32_32x32x16_bf16 v[72:87], v[60:63], a[52:55], v[72:87]
ds_read_b128 a[56:59], v15 offset:49152
ds_read_b64_tr_b16 v[48:49], v11 offset:36864
ds_read_b64_tr_b16 v[50:51], v11 offset:37632
s_waitcnt lgkmcnt(5)
v_mfma_f32_32x32x16_bf16 v[88:103], v[64:67], a[52:55], v[88:103]
ds_read_b64_tr_b16 v[52:53], v11 offset:36928
ds_read_b64_tr_b16 v[54:55], v11 offset:37696
s_waitcnt lgkmcnt(5)
v_mfma_f32_32x32x16_bf16 v[104:119], v[68:71], a[52:55], v[104:119]
ds_read_b64_tr_b16 v[56:57], v11 offset:36992
ds_read_b64_tr_b16 v[58:59], v11 offset:37760
s_waitcnt lgkmcnt(4)
v_mfma_f32_32x32x16_bf16 v[72:87], v[48:51], a[56:59], v[72:87]
ds_read_b128 a[60:63], v16 offset:49152
ds_read_b64_tr_b16 v[60:61], v12 offset:36864
ds_read_b64_tr_b16 v[62:63], v12 offset:37632
s_waitcnt lgkmcnt(5)
v_mfma_f32_32x32x16_bf16 v[88:103], v[52:55], a[56:59], v[88:103]
ds_read_b64_tr_b16 v[64:65], v12 offset:36928
ds_read_b64_tr_b16 v[66:67], v12 offset:37696
s_waitcnt lgkmcnt(5)
v_mfma_f32_32x32x16_bf16 v[104:119], v[56:59], a[56:59], v[104:119]
ds_read_b64_tr_b16 v[68:69], v12 offset:36992
ds_read_b64_tr_b16 v[70:71], v12 offset:37760
s_barrier
s_waitcnt lgkmcnt(4)
v_mfma_f32_32x32x16_bf16 v[72:87], v[60:63], a[60:63], v[72:87]
ds_read_b128 a[64:67], v13 offset:0
ds_read_b64_tr_b16 v[48:49], v9 offset:49152
ds_read_b64_tr_b16 v[50:51], v9 offset:49920
s_waitcnt lgkmcnt(5)
v_mfma_f32_32x32x16_bf16 v[88:103], v[64:67], a[60:63], v[88:103]
ds_read_b64_tr_b16 v[52:53], v9 offset:49216
ds_read_b64_tr_b16 v[54:55], v9 offset:49984
s_waitcnt lgkmcnt(5)
v_mfma_f32_32x32x16_bf16 v[104:119], v[68:71], a[60:63], v[104:119]
ds_read_b64_tr_b16 v[56:57], v9 offset:49280
ds_read_b64_tr_b16 v[58:59], v9 offset:50048
s_waitcnt lgkmcnt(4)
v_mfma_f32_32x32x16_bf16 v[72:87], v[48:51], a[64:67], v[72:87]
ds_read_b128 a[68:71], v14 offset:0
ds_read_b64_tr_b16 v[60:61], v10 offset:49152
ds_read_b64_tr_b16 v[62:63], v10 offset:49920
v_mfma_f32_16x16x32_bf16 v[36:39], v[32:35], v[48:51], v[36:39]
s_waitcnt lgkmcnt(5)
v_mfma_f32_32x32x16_bf16 v[88:103], v[52:55], a[64:67], v[88:103]
ds_read_b64_tr_b16 v[64:65], v10 offset:49216
ds_read_b64_tr_b16 v[66:67], v10 offset:49984
v_mfma_f32_16x16x32_bf16 v[40:43], v[32:35], v[52:55], v[40:43]
s_waitcnt lgkmcnt(5)
v_mfma_f32_32x32x16_bf16 v[104:119], v[56:59], a[64:67], v[104:119]
ds_read_b64_tr_b16 v[68:69], v10 offset:49280
ds_read_b64_tr_b16 v[70:71], v10 offset:50048
v_mfma_f32_16x16x32_bf16 v[44:47], v[32:35], v[56:59], v[44:47]
s_waitcnt lgkmcnt(4)
v_mfma_f32_32x32x16_bf16 v[72:87], v[60:63], a[68:71], v[72:87]
ds_read_b128 a[72:75], v15 offset:0
ds_read_b64_tr_b16 v[48:49], v11 offset:49152
ds_read_b64_tr_b16 v[50:51], v11 offset:49920
s_waitcnt lgkmcnt(5)
v_mfma_f32_32x32x16_bf16 v[88:103], v[64:67], a[68:71], v[88:103]
ds_read_b64_tr_b16 v[52:53], v11 offset:49216
ds_read_b64_tr_b16 v[54:55], v11 offset:49984
s_waitcnt lgkmcnt(5)
v_mfma_f32_32x32x16_bf16 v[104:119], v[68:71], a[68:71], v[104:119]
ds_read_b64_tr_b16 v[56:57], v11 offset:49280
ds_read_b64_tr_b16 v[58:59], v11 offset:50048
s_waitcnt lgkmcnt(4)
v_mfma_f32_32x32x16_bf16 v[72:87], v[48:51], a[72:75], v[72:87]
ds_read_b128 a[76:79], v16 offset:0
ds_read_b64_tr_b16 v[60:61], v12 offset:49152
ds_read_b64_tr_b16 v[62:63], v12 offset:49920
s_waitcnt lgkmcnt(5)
v_mfma_f32_32x32x16_bf16 v[88:103], v[52:55], a[72:75], v[88:103]
ds_read_b64_tr_b16 v[64:65], v12 offset:49216
ds_read_b64_tr_b16 v[66:67], v12 offset:49984
s_waitcnt lgkmcnt(5)
v_mfma_f32_32x32x16_bf16 v[104:119], v[56:59], a[72:75], v[104:119]
ds_read_b64_tr_b16 v[68:69], v12 offset:49280
ds_read_b64_tr_b16 v[70:71], v12 offset:50048
s_barrier
s_waitcnt lgkmcnt(4)
v_mfma_f32_32x32x16_bf16 v[72:87], v[60:63], a[76:79], v[72:87]
ds_read_b128 a[80:83], v13 offset:16384
ds_read_b64_tr_b16 v[48:49], v9 offset:61440
ds_read_b64_tr_b16 v[50:51], v9 offset:62208
s_waitcnt lgkmcnt(5)
v_mfma_f32_32x32x16_bf16 v[88:103], v[64:67], a[76:79], v[88:103]
ds_read_b64_tr_b16 v[52:53], v9 offset:61504
ds_read_b64_tr_b16 v[54:55], v9 offset:62272
s_waitcnt lgkmcnt(5)
v_mfma_f32_32x32x16_bf16 v[104:119], v[68:71], a[76:79], v[104:119]
ds_read_b64_tr_b16 v[56:57], v9 offset:61568
ds_read_b64_tr_b16 v[58:59], v9 offset:62336
v_and_b32 v2, 31, v1
v_lshlrev_b32 v25, 3, v2
s_lshl_b32 s50, s39, 8
s_add_u32 s50, s50, 15761408
buffer_load_dwordx2 v[120:121], v25, s[16:19], s50 offen sc1
s_waitcnt lgkmcnt(4)
v_mfma_f32_32x32x16_bf16 v[72:87], v[48:51], a[80:83], v[72:87]
ds_read_b128 a[84:87], v14 offset:16384
ds_read_b64_tr_b16 v[60:61], v10 offset:61440
ds_read_b64_tr_b16 v[62:63], v10 offset:62208
v_mfma_f32_16x16x32_bf16 v[36:39], v[32:35], v[48:51], v[36:39]
s_waitcnt lgkmcnt(5)
v_mfma_f32_32x32x16_bf16 v[88:103], v[52:55], a[80:83], v[88:103]
ds_read_b64_tr_b16 v[64:65], v10 offset:61504
ds_read_b64_tr_b16 v[66:67], v10 offset:62272
v_mfma_f32_16x16x32_bf16 v[40:43], v[32:35], v[52:55], v[40:43]
s_waitcnt lgkmcnt(5)
v_mfma_f32_32x32x16_bf16 v[104:119], v[56:59], a[80:83], v[104:119]
ds_read_b64_tr_b16 v[68:69], v10 offset:61568
ds_read_b64_tr_b16 v[70:71], v10 offset:62336
v_mfma_f32_16x16x32_bf16 v[44:47], v[32:35], v[56:59], v[44:47]
s_waitcnt lgkmcnt(4)
v_mfma_f32_32x32x16_bf16 v[72:87], v[60:63], a[84:87], v[72:87]
ds_read_b128 a[88:91], v15 offset:16384
ds_read_b64_tr_b16 v[48:49], v11 offset:61440
ds_read_b64_tr_b16 v[50:51], v11 offset:62208
s_waitcnt lgkmcnt(5)
v_mfma_f32_32x32x16_bf16 v[88:103], v[64:67], a[84:87], v[88:103]
ds_read_b64_tr_b16 v[52:53], v11 offset:61504
ds_read_b64_tr_b16 v[54:55], v11 offset:62272
s_waitcnt lgkmcnt(5)
v_mfma_f32_32x32x16_bf16 v[104:119], v[68:71], a[84:87], v[104:119]
ds_read_b64_tr_b16 v[56:57], v11 offset:61568
ds_read_b64_tr_b16 v[58:59], v11 offset:62336
s_waitcnt lgkmcnt(4)
v_mfma_f32_32x32x16_bf16 v[72:87], v[48:51], a[88:91], v[72:87]
ds_read_b128 a[92:95], v16 offset:16384
ds_read_b64_tr_b16 v[60:61], v12 offset:61440
ds_read_b64_tr_b16 v[62:63], v12 offset:62208
s_waitcnt lgkmcnt(5)
v_mfma_f32_32x32x16_bf16 v[88:103], v[52:55], a[88:91], v[88:103]
ds_read_b64_tr_b16 v[64:65], v12 offset:61504
ds_read_b64_tr_b16 v[66:67], v12 offset:62272
s_waitcnt lgkmcnt(5)
v_mfma_f32_32x32x16_bf16 v[104:119], v[56:59], a[88:91], v[104:119]
ds_read_b64_tr_b16 v[68:69], v12 offset:61568
ds_read_b64_tr_b16 v[70:71], v12 offset:62336
s_barrier
s_waitcnt lgkmcnt(4)
v_mfma_f32_32x32x16_bf16 v[72:87], v[60:63], a[92:95], v[72:87]
ds_read_b128 a[96:99], v13 offset:32768
ds_read_b64_tr_b16 v[48:49], v9 offset:0
ds_read_b64_tr_b16 v[50:51], v9 offset:768
s_waitcnt lgkmcnt(5)
v_mfma_f32_32x32x16_bf16 v[88:103], v[64:67], a[92:95], v[88:103]
ds_read_b64_tr_b16 v[52:53], v9 offset:64
ds_read_b64_tr_b16 v[54:55], v9 offset:832
s_waitcnt lgkmcnt(5)
v_mfma_f32_32x32x16_bf16 v[104:119], v[68:71], a[92:95], v[104:119]
ds_read_b64_tr_b16 v[56:57], v9 offset:128
ds_read_b64_tr_b16 v[58:59], v9 offset:896
s_waitcnt lgkmcnt(4)
v_mfma_f32_32x32x16_bf16 v[72:87], v[48:51], a[96:99], v[72:87]
ds_read_b128 a[100:103], v14 offset:32768
ds_read_b64_tr_b16 v[60:61], v10 offset:0
ds_read_b64_tr_b16 v[62:63], v10 offset:768
v_mfma_f32_16x16x32_bf16 v[36:39], v[32:35], v[48:51], v[36:39]
s_waitcnt lgkmcnt(5)
v_mfma_f32_32x32x16_bf16 v[88:103], v[52:55], a[96:99], v[88:103]
ds_read_b64_tr_b16 v[64:65], v10 offset:64
ds_read_b64_tr_b16 v[66:67], v10 offset:832
v_mfma_f32_16x16x32_bf16 v[40:43], v[32:35], v[52:55], v[40:43]
s_waitcnt lgkmcnt(5)
v_mfma_f32_32x32x16_bf16 v[104:119], v[56:59], a[96:99], v[104:119]
ds_read_b64_tr_b16 v[68:69], v10 offset:128
ds_read_b64_tr_b16 v[70:71], v10 offset:896
v_mfma_f32_16x16x32_bf16 v[44:47], v[32:35], v[56:59], v[44:47]
s_waitcnt lgkmcnt(4)
v_mfma_f32_32x32x16_bf16 v[72:87], v[60:63], a[100:103], v[72:87]
ds_read_b128 a[104:107], v15 offset:32768
ds_read_b64_tr_b16 v[48:49], v11 offset:0
ds_read_b64_tr_b16 v[50:51], v11 offset:768
s_waitcnt lgkmcnt(5)
v_mfma_f32_32x32x16_bf16 v[88:103], v[64:67], a[100:103], v[88:103]
ds_read_b64_tr_b16 v[52:53], v11 offset:64
ds_read_b64_tr_b16 v[54:55], v11 offset:832
s_waitcnt lgkmcnt(5)
v_mfma_f32_32x32x16_bf16 v[104:119], v[68:71], a[100:103], v[104:119]
ds_read_b64_tr_b16 v[56:57], v11 offset:128
ds_read_b64_tr_b16 v[58:59], v11 offset:896
s_waitcnt lgkmcnt(4)
v_mfma_f32_32x32x16_bf16 v[72:87], v[48:51], a[104:107], v[72:87]
ds_read_b128 a[108:111], v16 offset:32768
ds_read_b64_tr_b16 v[60:61], v12 offset:0
ds_read_b64_tr_b16 v[62:63], v12 offset:768
s_waitcnt lgkmcnt(5)
v_mfma_f32_32x32x16_bf16 v[88:103], v[52:55], a[104:107], v[88:103]
ds_read_b64_tr_b16 v[64:65], v12 offset:64
ds_read_b64_tr_b16 v[66:67], v12 offset:832
s_waitcnt lgkmcnt(5)
v_mfma_f32_32x32x16_bf16 v[104:119], v[56:59], a[104:107], v[104:119]
ds_read_b64_tr_b16 v[68:69], v12 offset:128
ds_read_b64_tr_b16 v[70:71], v12 offset:896
s_barrier
s_waitcnt lgkmcnt(4)
v_mfma_f32_32x32x16_bf16 v[72:87], v[60:63], a[108:111], v[72:87]
ds_read_b128 a[112:115], v13 offset:49152
ds_read_b64_tr_b16 v[48:49], v9 offset:12288
ds_read_b64_tr_b16 v[50:51], v9 offset:13056
s_waitcnt lgkmcnt(5)
v_mfma_f32_32x32x16_bf16 v[88:103], v[64:67], a[108:111], v[88:103]
ds_read_b64_tr_b16 v[52:53], v9 offset:12352
ds_read_b64_tr_b16 v[54:55], v9 offset:13120
s_waitcnt lgkmcnt(5)
v_mfma_f32_32x32x16_bf16 v[104:119], v[68:71], a[108:111], v[104:119]
ds_read_b64_tr_b16 v[56:57], v9 offset:12416
ds_read_b64_tr_b16 v[58:59], v9 offset:13184
s_waitcnt vmcnt(0)
v_cmp_ne_u32 vcc, s23, v121
s_nop 2
s_and_b64 s[56:57], vcc, exec
s_cbranch_scc1 Lp_7_stub
Lp_7:
v_lshlrev_b32 v26, 16, v120
v_and_b32 v28, 0xffff0000, v120
v_rcp_f32 v28, v28
v_xor_b32 v26, 0x80000000, v26
s_waitcnt lgkmcnt(4)
v_mfma_f32_32x32x16_bf16 v[72:87], v[48:51], a[112:115], v[72:87]
ds_read_b128 a[116:119], v14 offset:49152
ds_read_b64_tr_b16 v[60:61], v10 offset:12288
ds_read_b64_tr_b16 v[62:63], v10 offset:13056
v_mfma_f32_16x16x32_bf16 v[36:39], v[32:35], v[48:51], v[36:39]
s_waitcnt lgkmcnt(5)
v_mfma_f32_32x32x16_bf16 v[88:103], v[52:55], a[112:115], v[88:103]
ds_read_b64_tr_b16 v[64:65], v10 offset:12352
ds_read_b64_tr_b16 v[66:67], v10 offset:13120
v_mfma_f32_16x16x32_bf16 v[40:43], v[32:35], v[52:55], v[40:43]
s_waitcnt lgkmcnt(5)
v_mfma_f32_32x32x16_bf16 v[104:119], v[56:59], a[112:115], v[104:119]
ds_read_b64_tr_b16 v[68:69], v10 offset:12416
ds_read_b64_tr_b16 v[70:71], v10 offset:13184
v_mfma_f32_16x16x32_bf16 v[44:47], v[32:35], v[56:59], v[44:47]
s_waitcnt lgkmcnt(4)
v_mfma_f32_32x32x16_bf16 v[72:87], v[60:63], a[116:119], v[72:87]
ds_read_b128 a[120:123], v15 offset:49152
ds_read_b64_tr_b16 v[48:49], v11 offset:12288
ds_read_b64_tr_b16 v[50:51], v11 offset:13056
s_waitcnt lgkmcnt(5)
v_mfma_f32_32x32x16_bf16 v[88:103], v[64:67], a[116:119], v[88:103]
ds_read_b64_tr_b16 v[52:53], v11 offset:12352
ds_read_b64_tr_b16 v[54:55], v11 offset:13120
s_waitcnt lgkmcnt(5)
v_mfma_f32_32x32x16_bf16 v[104:119], v[68:71], a[116:119], v[104:119]
ds_read_b64_tr_b16 v[56:57], v11 offset:12416
ds_read_b64_tr_b16 v[58:59], v11 offset:13184
ds_write_b32 v17, v36 offset:0
ds_write_b32 v17, v40 offset:128
ds_write_b32 v17, v44 offset:256
s_waitcnt lgkmcnt(7)
v_mfma_f32_32x32x16_bf16 v[72:87], v[48:51], a[120:123], v[72:87]
ds_read_b128 a[124:127], v16 offset:49152
ds_read_b64_tr_b16 v[60:61], v12 offset:12288
ds_read_b64_tr_b16 v[62:63], v12 offset:13056
s_waitcnt lgkmcnt(8)
v_mfma_f32_32x32x16_bf16 v[88:103], v[52:55], a[120:123], v[88:103]
ds_read_b64_tr_b16 v[64:65], v12 offset:12352
ds_read_b64_tr_b16 v[66:67], v12 offset:13120
s_waitcnt lgkmcnt(8)
v_mfma_f32_32x32x16_bf16 v[104:119], v[56:59], a[120:123], v[104:119]
ds_read_b64_tr_b16 v[68:69], v12 offset:12416
ds_read_b64_tr_b16 v[70:71], v12 offset:13184
s_waitcnt lgkmcnt(7)
s_barrier
s_waitcnt lgkmcnt(4)
v_mfma_f32_32x32x16_bf16 v[72:87], v[60:63], a[124:127], v[72:87]
ds_read_b64_tr_b16 v[48:49], v9 offset:24576
ds_read_b64_tr_b16 v[50:51], v9 offset:25344
s_waitcnt lgkmcnt(4)
v_mfma_f32_32x32x16_bf16 v[88:103], v[64:67], a[124:127], v[88:103]
ds_read_b64_tr_b16 v[52:53], v9 offset:24640
ds_read_b64_tr_b16 v[54:55], v9 offset:25408
s_waitcnt lgkmcnt(4)
v_mfma_f32_32x32x16_bf16 v[104:119], v[68:71], a[124:127], v[104:119]
ds_read_b64_tr_b16 v[56:57], v9 offset:24704
ds_read_b64_tr_b16 v[58:59], v9 offset:25472
ds_read_b32 v36, v18 offset:0
ds_read_b32 v37, v18 offset:384
ds_read_b32 v38, v18 offset:768
ds_read_b32 v39, v18 offset:1152
ds_read_b32 v40, v18 offset:256
ds_read_b32 v41, v18 offset:640
ds_read_b32 v42, v18 offset:1024
ds_read_b32 v43, v18 offset:1408
s_waitcnt lgkmcnt(0)
v_add_f32 v36, v36, v37
v_add_f32 v38, v38, v39
v_add_f32 v40, v40, v41
v_add_f32 v42, v42, v43
v_add_f32 v36, v36, v38
v_add_f32 v40, v40, v42
ds_write_b32 v19, v36
s_mov_b32 exec_hi, 0
ds_write_b32 v19, v40 offset:256
s_mov_b32 exec_hi, -1
s_nop 3
ds_read_b128 v[36:39], v20 offset:0
ds_read_b128 v[40:43], v20 offset:32
ds_read_b128 v[44:47], v20 offset:64
ds_read_b128 v[120:123], v20 offset:96
v_mul_f32 v30, s44, v28
s_waitcnt lgkmcnt(0)
v_pk_fma_f32 v[72:73], v[36:37], v[26:27], v[72:73] op_sel_hi:[1,0,1]
v_pk_fma_f32 v[74:75], v[38:39], v[26:27], v[74:75] op_sel_hi:[1,0,1]
v_pk_fma_f32 v[76:77], v[40:41], v[26:27], v[76:77] op_sel_hi:[1,0,1]
v_pk_fma_f32 v[78:79], v[42:43], v[26:27], v[78:79] op_sel_hi:[1,0,1]
v_pk_fma_f32 v[80:81], v[44:45], v[26:27], v[80:81] op_sel_hi:[1,0,1]
v_pk_fma_f32 v[82:83], v[46:47], v[26:27], v[82:83] op_sel_hi:[1,0,1]
v_pk_fma_f32 v[84:85], v[120:121], v[26:27], v[84:85] op_sel_hi:[1,0,1]
v_pk_fma_f32 v[86:87], v[122:123], v[26:27], v[86:87] op_sel_hi:[1,0,1]
ds_read_b128 v[36:39], v20 offset:128
ds_read_b128 v[40:43], v20 offset:160
ds_read_b128 v[44:47], v20 offset:192
ds_read_b128 v[120:123], v20 offset:224
v_pk_mul_f32 v[72:73], v[72:73], v[30:31] op_sel_hi:[1,0]
v_pk_mul_f32 v[74:75], v[74:75], v[30:31] op_sel_hi:[1,0]
v_pk_mul_f32 v[76:77], v[76:77], v[30:31] op_sel_hi:[1,0]
v_pk_mul_f32 v[78:79], v[78:79], v[30:31] op_sel_hi:[1,0]
v_pk_mul_f32 v[80:81], v[80:81], v[30:31] op_sel_hi:[1,0]
v_pk_mul_f32 v[82:83], v[82:83], v[30:31] op_sel_hi:[1,0]
v_pk_mul_f32 v[84:85], v[84:85], v[30:31] op_sel_hi:[1,0]
v_pk_mul_f32 v[86:87], v[86:87], v[30:31] op_sel_hi:[1,0]
v_cvt_pk_bf16_f32 v60, v72, v73
v_cvt_pk_bf16_f32 v61, v74, v75
v_cvt_pk_bf16_f32 v62, v76, v77
v_cvt_pk_bf16_f32 v63, v78, v79
v_cvt_pk_bf16_f32 v64, v80, v81
v_cvt_pk_bf16_f32 v65, v82, v83
v_cvt_pk_bf16_f32 v66, v84, v85
v_cvt_pk_bf16_f32 v67, v86, v87
buffer_store_dwordx4 v[60:63], v21, s[16:19], s40 offen sc1
s_add_u32 s40, s40, 65536
buffer_store_dwordx4 v[64:67], v21, s[16:19], s40 offen sc1
v_mul_f32 v30, s45, v28
s_waitcnt lgkmcnt(0)
v_pk_fma_f32 v[88:89], v[36:37], v[26:27], v[88:89] op_sel_hi:[1,0,1]
v_pk_fma_f32 v[90:91], v[38:39], v[26:27], v[90:91] op_sel_hi:[1,0,1]
v_pk_fma_f32 v[92:93], v[40:41], v[26:27], v[92:93] op_sel_hi:[1,0,1]
v_pk_fma_f32 v[94:95], v[42:43], v[26:27], v[94:95] op_sel_hi:[1,0,1]
v_pk_fma_f32 v[96:97], v[44:45], v[26:27], v[96:97] op_sel_hi:[1,0,1]
v_pk_fma_f32 v[98:99], v[46:47], v[26:27], v[98:99] op_sel_hi:[1,0,1]
v_pk_fma_f32 v[100:101], v[120:121], v[26:27], v[100:101] op_sel_hi:[1,0,1]
v_pk_fma_f32 v[102:103], v[122:123], v[26:27], v[102:103] op_sel_hi:[1,0,1]
ds_read_b128 v[36:39], v20 offset:256
ds_read_b128 v[40:43], v20 offset:288
ds_read_b128 v[44:47], v20 offset:320
ds_read_b128 v[120:123], v20 offset:352
v_pk_mul_f32 v[88:89], v[88:89], v[30:31] op_sel_hi:[1,0]
v_pk_mul_f32 v[90:91], v[90:91], v[30:31] op_sel_hi:[1,0]
v_pk_mul_f32 v[92:93], v[92:93], v[30:31] op_sel_hi:[1,0]
v_pk_mul_f32 v[94:95], v[94:95], v[30:31] op_sel_hi:[1,0]
v_pk_mul_f32 v[96:97], v[96:97], v[30:31] op_sel_hi:[1,0]
v_pk_mul_f32 v[98:99], v[98:99], v[30:31] op_sel_hi:[1,0]
v_pk_mul_f32 v[100:101], v[100:101], v[30:31] op_sel_hi:[1,0]
v_pk_mul_f32 v[102:103], v[102:103], v[30:31] op_sel_hi:[1,0]
v_cvt_pk_bf16_f32 v60, v88, v89
v_cvt_pk_bf16_f32 v61, v90, v91
v_cvt_pk_bf16_f32 v62, v92, v93
v_cvt_pk_bf16_f32 v63, v94, v95
v_cvt_pk_bf16_f32 v64, v96, v97
v_cvt_pk_bf16_f32 v65, v98, v99
v_cvt_pk_bf16_f32 v66, v100, v101
v_cvt_pk_bf16_f32 v67, v102, v103
buffer_store_dwordx4 v[60:63], v22, s[16:19], s41 offen sc1
s_add_u32 s41, s41, 65536
buffer_store_dwordx4 v[64:67], v22, s[16:19], s41 offen sc1
v_mul_f32 v30, s46, v28
s_waitcnt lgkmcnt(0)
v_pk_fma_f32 v[104:105], v[36:37], v[26:27], v[104:105] op_sel_hi:[1,0,1]
v_pk_fma_f32 v[106:107], v[38:39], v[26:27], v[106:107] op_sel_hi:[1,0,1]
v_pk_fma_f32 v[108:109], v[40:41], v[26:27], v[108:109] op_sel_hi:[1,0,1]
v_pk_fma_f32 v[110:111], v[42:43], v[26:27], v[110:111] op_sel_hi:[1,0,1]
v_pk_fma_f32 v[112:113], v[44:45], v[26:27], v[112:113] op_sel_hi:[1,0,1]
v_pk_fma_f32 v[114:115], v[46:47], v[26:27], v[114:115] op_sel_hi:[1,0,1]
v_pk_fma_f32 v[116:117], v[120:121], v[26:27], v[116:117] op_sel_hi:[1,0,1]
v_pk_fma_f32 v[118:119], v[122:123], v[26:27], v[118:119] op_sel_hi:[1,0,1]
v_pk_mul_f32 v[104:105], v[104:105], v[30:31] op_sel_hi:[1,0]
v_pk_mul_f32 v[106:107], v[106:107], v[30:31] op_sel_hi:[1,0]
v_pk_mul_f32 v[108:109], v[108:109], v[30:31] op_sel_hi:[1,0]
v_pk_mul_f32 v[110:111], v[110:111], v[30:31] op_sel_hi:[1,0]
v_pk_mul_f32 v[112:113], v[112:113], v[30:31] op_sel_hi:[1,0]
v_pk_mul_f32 v[114:115], v[114:115], v[30:31] op_sel_hi:[1,0]
v_pk_mul_f32 v[116:117], v[116:117], v[30:31] op_sel_hi:[1,0]
v_pk_mul_f32 v[118:119], v[118:119], v[30:31] op_sel_hi:[1,0]
v_cvt_pk_bf16_f32 v60, v104, v105
v_cvt_pk_bf16_f32 v61, v106, v107
v_cvt_pk_bf16_f32 v62, v108, v109
v_cvt_pk_bf16_f32 v63, v110, v111
v_cvt_pk_bf16_f32 v64, v112, v113
v_cvt_pk_bf16_f32 v65, v114, v115
v_cvt_pk_bf16_f32 v66, v116, v117
v_cvt_pk_bf16_f32 v67, v118, v119
buffer_store_dwordx4 v[60:63], v23, s[16:19], s42 offen sc1
s_add_u32 s42, s42, 65536
buffer_store_dwordx4 v[64:67], v23, s[16:19], s42 offen sc1
v_mfma_f32_32x32x16_bf16 v[72:87], v[48:51], a[0:3], 0
ds_read_b64_tr_b16 v[60:61], v10 offset:24576
ds_read_b64_tr_b16 v[62:63], v10 offset:25344
v_mfma_f32_16x16x32_bf16 v[36:39], v[32:35], v[48:51], 0
v_mfma_f32_32x32x16_bf16 v[88:103], v[52:55], a[0:3], 0
ds_read_b64_tr_b16 v[64:65], v10 offset:24640
ds_read_b64_tr_b16 v[66:67], v10 offset:25408
v_mfma_f32_16x16x32_bf16 v[40:43], v[32:35], v[52:55], 0
v_mfma_f32_32x32x16_bf16 v[104:119], v[56:59], a[0:3], 0
ds_read_b64_tr_b16 v[68:69], v10 offset:24704
ds_read_b64_tr_b16 v[70:71], v10 offset:25472
v_mfma_f32_16x16x32_bf16 v[44:47], v[32:35], v[56:59], 0
s_waitcnt lgkmcnt(4)
v_mfma_f32_32x32x16_bf16 v[72:87], v[60:63], a[4:7], v[72:87]
ds_read_b64_tr_b16 v[48:49], v11 offset:24576
ds_read_b64_tr_b16 v[50:51], v11 offset:25344
s_waitcnt lgkmcnt(4)
v_mfma_f32_32x32x16_bf16 v[88:103], v[64:67], a[4:7], v[88:103]
ds_read_b64_tr_b16 v[52:53], v11 offset:24640
ds_read_b64_tr_b16 v[54:55], v11 offset:25408
s_waitcnt lgkmcnt(4)
v_mfma_f32_32x32x16_bf16 v[104:119], v[68:71], a[4:7], v[104:119]
ds_read_b64_tr_b16 v[56:57], v11 offset:24704
ds_read_b64_tr_b16 v[58:59], v11 offset:25472
s_waitcnt lgkmcnt(4)
v_mfma_f32_32x32x16_bf16 v[72:87], v[48:51], a[8:11], v[72:87]
ds_read_b64_tr_b16 v[60:61], v12 offset:24576
ds_read_b64_tr_b16 v[62:63], v12 offset:25344
s_waitcnt lgkmcnt(4)
v_mfma_f32_32x32x16_bf16 v[88:103], v[52:55], a[8:11], v[88:103]
ds_read_b64_tr_b16 v[64:65], v12 offset:24640
ds_read_b64_tr_b16 v[66:67], v12 offset:25408
s_waitcnt lgkmcnt(4)
v_mfma_f32_32x32x16_bf16 v[104:119], v[56:59], a[8:11], v[104:119]
ds_read_b64_tr_b16 v[68:69], v12 offset:24704
ds_read_b64_tr_b16 v[70:71], v12 offset:25472
s_barrier
s_waitcnt lgkmcnt(4)
v_mfma_f32_32x32x16_bf16 v[72:87], v[60:63], a[12:15], v[72:87]
ds_read_b64_tr_b16 v[48:49], v9 offset:36864
ds_read_b64_tr_b16 v[50:51], v9 offset:37632
s_waitcnt lgkmcnt(4)
v_mfma_f32_32x32x16_bf16 v[88:103], v[64:67], a[12:15], v[88:103]
ds_read_b64_tr_b16 v[52:53], v9 offset:36928
ds_read_b64_tr_b16 v[54:55], v9 offset:37696
s_waitcnt lgkmcnt(4)
v_mfma_f32_32x32x16_bf16 v[104:119], v[68:71], a[12:15], v[104:119]
ds_read_b64_tr_b16 v[56:57], v9 offset:36992
ds_read_b64_tr_b16 v[58:59], v9 offset:37760
s_waitcnt lgkmcnt(4)
v_mfma_f32_32x32x16_bf16 v[72:87], v[48:51], a[16:19], v[72:87]
ds_read_b64_tr_b16 v[60:61], v10 offset:36864
ds_read_b64_tr_b16 v[62:63], v10 offset:37632
v_mfma_f32_16x16x32_bf16 v[36:39], v[32:35], v[48:51], v[36:39]
s_waitcnt lgkmcnt(4)
v_mfma_f32_32x32x16_bf16 v[88:103], v[52:55], a[16:19], v[88:103]
ds_read_b64_tr_b16 v[64:65], v10 offset:36928
ds_read_b64_tr_b16 v[66:67], v10 offset:37696
v_mfma_f32_16x16x32_bf16 v[40:43], v[32:35], v[52:55], v[40:43]
s_waitcnt lgkmcnt(4)
v_mfma_f32_32x32x16_bf16 v[104:119], v[56:59], a[16:19], v[104:119]
ds_read_b64_tr_b16 v[68:69], v10 offset:36992
ds_read_b64_tr_b16 v[70:71], v10 offset:37760
v_mfma_f32_16x16x32_bf16 v[44:47], v[32:35], v[56:59], v[44:47]
s_waitcnt lgkmcnt(4)
v_mfma_f32_32x32x16_bf16 v[72:87], v[60:63], a[20:23], v[72:87]
ds_read_b64_tr_b16 v[48:49], v11 offset:36864
ds_read_b64_tr_b16 v[50:51], v11 offset:37632
s_waitcnt lgkmcnt(4)
v_mfma_f32_32x32x16_bf16 v[88:103], v[64:67], a[20:23], v[88:103]
ds_read_b64_tr_b16 v[52:53], v11 offset:36928
ds_read_b64_tr_b16 v[54:55], v11 offset:37696
s_waitcnt lgkmcnt(4)
v_mfma_f32_32x32x16_bf16 v[104:119], v[68:71], a[20:23], v[104:119]
ds_read_b64_tr_b16 v[56:57], v11 offset:36992
ds_read_b64_tr_b16 v[58:59], v11 offset:37760
s_waitcnt lgkmcnt(4)
v_mfma_f32_32x32x16_bf16 v[72:87], v[48:51], a[24:27], v[72:87]
ds_read_b64_tr_b16 v[60:61], v12 offset:36864
ds_read_b64_tr_b16 v[62:63], v12 offset:37632
s_waitcnt lgkmcnt(4)
v_mfma_f32_32x32x16_bf16 v[88:103], v[52:55], a[24:27], v[88:103]
ds_read_b64_tr_b16 v[64:65], v12 offset:36928
ds_read_b64_tr_b16 v[66:67], v12 offset:37696
s_waitcnt lgkmcnt(4)
v_mfma_f32_32x32x16_bf16 v[104:119], v[56:59], a[24:27], v[104:119]
ds_read_b64_tr_b16 v[68:69], v12 offset:36992
ds_read_b64_tr_b16 v[70:71], v12 offset:37760
s_waitcnt vmcnt(0)
s_barrier
s_waitcnt lgkmcnt(4)
v_mfma_f32_32x32x16_bf16 v[72:87], v[60:63], a[28:31], v[72:87]
ds_read_b64_tr_b16 v[48:49], v9 offset:49152
ds_read_b64_tr_b16 v[50:51], v9 offset:49920
s_waitcnt lgkmcnt(4)
v_mfma_f32_32x32x16_bf16 v[88:103], v[64:67], a[28:31], v[88:103]
ds_read_b64_tr_b16 v[52:53], v9 offset:49216
ds_read_b64_tr_b16 v[54:55], v9 offset:49984
s_waitcnt lgkmcnt(4)
v_mfma_f32_32x32x16_bf16 v[104:119], v[68:71], a[28:31], v[104:119]
ds_read_b64_tr_b16 v[56:57], v9 offset:49280
ds_read_b64_tr_b16 v[58:59], v9 offset:50048
s_waitcnt lgkmcnt(4)
v_mfma_f32_32x32x16_bf16 v[72:87], v[48:51], a[32:35], v[72:87]
ds_read_b64_tr_b16 v[60:61], v10 offset:49152
ds_read_b64_tr_b16 v[62:63], v10 offset:49920
v_mfma_f32_16x16x32_bf16 v[36:39], v[32:35], v[48:51], v[36:39]
s_waitcnt lgkmcnt(4)
v_mfma_f32_32x32x16_bf16 v[88:103], v[52:55], a[32:35], v[88:103]
ds_read_b64_tr_b16 v[64:65], v10 offset:49216
ds_read_b64_tr_b16 v[66:67], v10 offset:49984
v_mfma_f32_16x16x32_bf16 v[40:43], v[32:35], v[52:55], v[40:43]
s_waitcnt lgkmcnt(4)
v_mfma_f32_32x32x16_bf16 v[104:119], v[56:59], a[32:35], v[104:119]
ds_read_b64_tr_b16 v[68:69], v10 offset:49280
ds_read_b64_tr_b16 v[70:71], v10 offset:50048
v_mfma_f32_16x16x32_bf16 v[44:47], v[32:35], v[56:59], v[44:47]
s_waitcnt lgkmcnt(4)
v_mfma_f32_32x32x16_bf16 v[72:87], v[60:63], a[36:39], v[72:87]
ds_read_b64_tr_b16 v[48:49], v11 offset:49152
ds_read_b64_tr_b16 v[50:51], v11 offset:49920
s_waitcnt lgkmcnt(4)
v_mfma_f32_32x32x16_bf16 v[88:103], v[64:67], a[36:39], v[88:103]
ds_read_b64_tr_b16 v[52:53], v11 offset:49216
ds_read_b64_tr_b16 v[54:55], v11 offset:49984
s_waitcnt lgkmcnt(4)
v_mfma_f32_32x32x16_bf16 v[104:119], v[68:71], a[36:39], v[104:119]
ds_read_b64_tr_b16 v[56:57], v11 offset:49280
ds_read_b64_tr_b16 v[58:59], v11 offset:50048
s_waitcnt lgkmcnt(4)
v_mfma_f32_32x32x16_bf16 v[72:87], v[48:51], a[40:43], v[72:87]
ds_read_b64_tr_b16 v[60:61], v12 offset:49152
ds_read_b64_tr_b16 v[62:63], v12 offset:49920
s_waitcnt lgkmcnt(4)
v_mfma_f32_32x32x16_bf16 v[88:103], v[52:55], a[40:43], v[88:103]
ds_read_b64_tr_b16 v[64:65], v12 offset:49216
ds_read_b64_tr_b16 v[66:67], v12 offset:49984
s_waitcnt lgkmcnt(4)
v_mfma_f32_32x32x16_bf16 v[104:119], v[56:59], a[40:43], v[104:119]
ds_read_b64_tr_b16 v[68:69], v12 offset:49280
ds_read_b64_tr_b16 v[70:71], v12 offset:50048
s_barrier
s_waitcnt lgkmcnt(4)
v_mfma_f32_32x32x16_bf16 v[72:87], v[60:63], a[44:47], v[72:87]
ds_read_b64_tr_b16 v[48:49], v9 offset:61440
ds_read_b64_tr_b16 v[50:51], v9 offset:62208
s_waitcnt lgkmcnt(4)
v_mfma_f32_32x32x16_bf16 v[88:103], v[64:67], a[44:47], v[88:103]
ds_read_b64_tr_b16 v[52:53], v9 offset:61504
ds_read_b64_tr_b16 v[54:55], v9 offset:62272
s_waitcnt lgkmcnt(4)
v_mfma_f32_32x32x16_bf16 v[104:119], v[68:71], a[44:47], v[104:119]
ds_read_b64_tr_b16 v[56:57], v9 offset:61568
ds_read_b64_tr_b16 v[58:59], v9 offset:62336
s_waitcnt lgkmcnt(4)
v_mfma_f32_32x32x16_bf16 v[72:87], v[48:51], a[48:51], v[72:87]
ds_read_b64_tr_b16 v[60:61], v10 offset:61440
ds_read_b64_tr_b16 v[62:63], v10 offset:62208
v_mfma_f32_16x16x32_bf16 v[36:39], v[32:35], v[48:51], v[36:39]
s_waitcnt lgkmcnt(4)
v_mfma_f32_32x32x16_bf16 v[88:103], v[52:55], a[48:51], v[88:103]
ds_read_b64_tr_b16 v[64:65], v10 offset:61504
ds_read_b64_tr_b16 v[66:67], v10 offset:62272
v_mfma_f32_16x16x32_bf16 v[40:43], v[32:35], v[52:55], v[40:43]
s_waitcnt lgkmcnt(4)
v_mfma_f32_32x32x16_bf16 v[104:119], v[56:59], a[48:51], v[104:119]
ds_read_b64_tr_b16 v[68:69], v10 offset:61568
ds_read_b64_tr_b16 v[70:71], v10 offset:62336
v_mfma_f32_16x16x32_bf16 v[44:47], v[32:35], v[56:59], v[44:47]
s_waitcnt lgkmcnt(4)
v_mfma_f32_32x32x16_bf16 v[72:87], v[60:63], a[52:55], v[72:87]
ds_read_b64_tr_b16 v[48:49], v11 offset:61440
ds_read_b64_tr_b16 v[50:51], v11 offset:62208
s_waitcnt lgkmcnt(4)
v_mfma_f32_32x32x16_bf16 v[88:103], v[64:67], a[52:55], v[88:103]
ds_read_b64_tr_b16 v[52:53], v11 offset:61504
ds_read_b64_tr_b16 v[54:55], v11 offset:62272
s_waitcnt lgkmcnt(4)
v_mfma_f32_32x32x16_bf16 v[104:119], v[68:71], a[52:55], v[104:119]
ds_read_b64_tr_b16 v[56:57], v11 offset:61568
ds_read_b64_tr_b16 v[58:59], v11 offset:62336
s_waitcnt lgkmcnt(4)
v_mfma_f32_32x32x16_bf16 v[72:87], v[48:51], a[56:59], v[72:87]
ds_read_b64_tr_b16 v[60:61], v12 offset:61440
ds_read_b64_tr_b16 v[62:63], v12 offset:62208
s_waitcnt lgkmcnt(4)
v_mfma_f32_32x32x16_bf16 v[88:103], v[52:55], a[56:59], v[88:103]
ds_read_b64_tr_b16 v[64:65], v12 offset:61504
ds_read_b64_tr_b16 v[66:67], v12 offset:62272
s_waitcnt lgkmcnt(4)
v_mfma_f32_32x32x16_bf16 v[104:119], v[56:59], a[56:59], v[104:119]
ds_read_b64_tr_b16 v[68:69], v12 offset:61568
ds_read_b64_tr_b16 v[70:71], v12 offset:62336
s_barrier
s_waitcnt lgkmcnt(4)
v_mfma_f32_32x32x16_bf16 v[72:87], v[60:63], a[60:63], v[72:87]
ds_read_b64_tr_b16 v[48:49], v9 offset:0
ds_read_b64_tr_b16 v[50:51], v9 offset:768
s_waitcnt lgkmcnt(4)
v_mfma_f32_32x32x16_bf16 v[88:103], v[64:67], a[60:63], v[88:103]
ds_read_b64_tr_b16 v[52:53], v9 offset:64
ds_read_b64_tr_b16 v[54:55], v9 offset:832
s_waitcnt lgkmcnt(4)
v_mfma_f32_32x32x16_bf16 v[104:119], v[68:71], a[60:63], v[104:119]
ds_read_b64_tr_b16 v[56:57], v9 offset:128
ds_read_b64_tr_b16 v[58:59], v9 offset:896
s_waitcnt lgkmcnt(4)
v_mfma_f32_32x32x16_bf16 v[72:87], v[48:51], a[64:67], v[72:87]
ds_read_b64_tr_b16 v[60:61], v10 offset:0
ds_read_b64_tr_b16 v[62:63], v10 offset:768
v_mfma_f32_16x16x32_bf16 v[36:39], v[32:35], v[48:51], v[36:39]
s_waitcnt lgkmcnt(4)
v_mfma_f32_32x32x16_bf16 v[88:103], v[52:55], a[64:67], v[88:103]
ds_read_b64_tr_b16 v[64:65], v10 offset:64
ds_read_b64_tr_b16 v[66:67], v10 offset:832
v_mfma_f32_16x16x32_bf16 v[40:43], v[32:35], v[52:55], v[40:43]
s_waitcnt lgkmcnt(4)
v_mfma_f32_32x32x16_bf16 v[104:119], v[56:59], a[64:67], v[104:119]
ds_read_b64_tr_b16 v[68:69], v10 offset:128
ds_read_b64_tr_b16 v[70:71], v10 offset:896
v_mfma_f32_16x16x32_bf16 v[44:47], v[32:35], v[56:59], v[44:47]
s_waitcnt lgkmcnt(4)
v_mfma_f32_32x32x16_bf16 v[72:87], v[60:63], a[68:71], v[72:87]
ds_read_b64_tr_b16 v[48:49], v11 offset:0
ds_read_b64_tr_b16 v[50:51], v11 offset:768
s_waitcnt lgkmcnt(4)
v_mfma_f32_32x32x16_bf16 v[88:103], v[64:67], a[68:71], v[88:103]
ds_read_b64_tr_b16 v[52:53], v11 offset:64
ds_read_b64_tr_b16 v[54:55], v11 offset:832
s_waitcnt lgkmcnt(4)
v_mfma_f32_32x32x16_bf16 v[104:119], v[68:71], a[68:71], v[104:119]
ds_read_b64_tr_b16 v[56:57], v11 offset:128
ds_read_b64_tr_b16 v[58:59], v11 offset:896
s_waitcnt lgkmcnt(4)
v_mfma_f32_32x32x16_bf16 v[72:87], v[48:51], a[72:75], v[72:87]
ds_read_b64_tr_b16 v[60:61], v12 offset:0
ds_read_b64_tr_b16 v[62:63], v12 offset:768
s_waitcnt lgkmcnt(4)
v_mfma_f32_32x32x16_bf16 v[88:103], v[52:55], a[72:75], v[88:103]
ds_read_b64_tr_b16 v[64:65], v12 offset:64
ds_read_b64_tr_b16 v[66:67], v12 offset:832
s_waitcnt lgkmcnt(4)
v_mfma_f32_32x32x16_bf16 v[104:119], v[56:59], a[72:75], v[104:119]
ds_read_b64_tr_b16 v[68:69], v12 offset:128
ds_read_b64_tr_b16 v[70:71], v12 offset:896
s_barrier
s_waitcnt lgkmcnt(4)
v_mfma_f32_32x32x16_bf16 v[72:87], v[60:63], a[76:79], v[72:87]
ds_read_b64_tr_b16 v[48:49], v9 offset:12288
ds_read_b64_tr_b16 v[50:51], v9 offset:13056
s_waitcnt lgkmcnt(4)
v_mfma_f32_32x32x16_bf16 v[88:103], v[64:67], a[76:79], v[88:103]
ds_read_b64_tr_b16 v[52:53], v9 offset:12352
ds_read_b64_tr_b16 v[54:55], v9 offset:13120
s_waitcnt lgkmcnt(4)
v_mfma_f32_32x32x16_bf16 v[104:119], v[68:71], a[76:79], v[104:119]
ds_read_b64_tr_b16 v[56:57], v9 offset:12416
ds_read_b64_tr_b16 v[58:59], v9 offset:13184
s_waitcnt lgkmcnt(4)
v_mfma_f32_32x32x16_bf16 v[72:87], v[48:51], a[80:83], v[72:87]
ds_read_b64_tr_b16 v[60:61], v10 offset:12288
ds_read_b64_tr_b16 v[62:63], v10 offset:13056
v_mfma_f32_16x16x32_bf16 v[36:39], v[32:35], v[48:51], v[36:39]
s_waitcnt lgkmcnt(4)
v_mfma_f32_32x32x16_bf16 v[88:103], v[52:55], a[80:83], v[88:103]
ds_read_b64_tr_b16 v[64:65], v10 offset:12352
ds_read_b64_tr_b16 v[66:67], v10 offset:13120
v_mfma_f32_16x16x32_bf16 v[40:43], v[32:35], v[52:55], v[40:43]
s_waitcnt lgkmcnt(4)
v_mfma_f32_32x32x16_bf16 v[104:119], v[56:59], a[80:83], v[104:119]
ds_read_b64_tr_b16 v[68:69], v10 offset:12416
ds_read_b64_tr_b16 v[70:71], v10 offset:13184
v_mfma_f32_16x16x32_bf16 v[44:47], v[32:35], v[56:59], v[44:47]
s_waitcnt lgkmcnt(4)
v_mfma_f32_32x32x16_bf16 v[72:87], v[60:63], a[84:87], v[72:87]
ds_read_b64_tr_b16 v[48:49], v11 offset:12288
ds_read_b64_tr_b16 v[50:51], v11 offset:13056
s_waitcnt lgkmcnt(4)
v_mfma_f32_32x32x16_bf16 v[88:103], v[64:67], a[84:87], v[88:103]
ds_read_b64_tr_b16 v[52:53], v11 offset:12352
ds_read_b64_tr_b16 v[54:55], v11 offset:13120
s_waitcnt lgkmcnt(4)
v_mfma_f32_32x32x16_bf16 v[104:119], v[68:71], a[84:87], v[104:119]
ds_read_b64_tr_b16 v[56:57], v11 offset:12416
ds_read_b64_tr_b16 v[58:59], v11 offset:13184
s_waitcnt lgkmcnt(4)
v_mfma_f32_32x32x16_bf16 v[72:87], v[48:51], a[88:91], v[72:87]
ds_read_b64_tr_b16 v[60:61], v12 offset:12288
ds_read_b64_tr_b16 v[62:63], v12 offset:13056
s_waitcnt lgkmcnt(4)
v_mfma_f32_32x32x16_bf16 v[88:103], v[52:55], a[88:91], v[88:103]
ds_read_b64_tr_b16 v[64:65], v12 offset:12352
ds_read_b64_tr_b16 v[66:67], v12 offset:13120
s_waitcnt lgkmcnt(4)
v_mfma_f32_32x32x16_bf16 v[104:119], v[56:59], a[88:91], v[104:119]
ds_read_b64_tr_b16 v[68:69], v12 offset:12416
ds_read_b64_tr_b16 v[70:71], v12 offset:13184
s_barrier
s_waitcnt lgkmcnt(4)
v_mfma_f32_32x32x16_bf16 v[72:87], v[60:63], a[92:95], v[72:87]
ds_read_b64_tr_b16 v[48:49], v9 offset:24576
ds_read_b64_tr_b16 v[50:51], v9 offset:25344
s_waitcnt lgkmcnt(4)
v_mfma_f32_32x32x16_bf16 v[88:103], v[64:67], a[92:95], v[88:103]
ds_read_b64_tr_b16 v[52:53], v9 offset:24640
ds_read_b64_tr_b16 v[54:55], v9 offset:25408
s_waitcnt lgkmcnt(4)
v_mfma_f32_32x32x16_bf16 v[104:119], v[68:71], a[92:95], v[104:119]
ds_read_b64_tr_b16 v[56:57], v9 offset:24704
ds_read_b64_tr_b16 v[58:59], v9 offset:25472
s_waitcnt lgkmcnt(4)
v_mfma_f32_32x32x16_bf16 v[72:87], v[48:51], a[96:99], v[72:87]
ds_read_b64_tr_b16 v[60:61], v10 offset:24576
ds_read_b64_tr_b16 v[62:63], v10 offset:25344
v_mfma_f32_16x16x32_bf16 v[36:39], v[32:35], v[48:51], v[36:39]
s_waitcnt lgkmcnt(4)
v_mfma_f32_32x32x16_bf16 v[88:103], v[52:55], a[96:99], v[88:103]
ds_read_b64_tr_b16 v[64:65], v10 offset:24640
ds_read_b64_tr_b16 v[66:67], v10 offset:25408
v_mfma_f32_16x16x32_bf16 v[40:43], v[32:35], v[52:55], v[40:43]
s_waitcnt lgkmcnt(4)
v_mfma_f32_32x32x16_bf16 v[104:119], v[56:59], a[96:99], v[104:119]
ds_read_b64_tr_b16 v[68:69], v10 offset:24704
ds_read_b64_tr_b16 v[70:71], v10 offset:25472
v_mfma_f32_16x16x32_bf16 v[44:47], v[32:35], v[56:59], v[44:47]
s_waitcnt lgkmcnt(4)
v_mfma_f32_32x32x16_bf16 v[72:87], v[60:63], a[100:103], v[72:87]
ds_read_b64_tr_b16 v[48:49], v11 offset:24576
ds_read_b64_tr_b16 v[50:51], v11 offset:25344
s_waitcnt lgkmcnt(4)
v_mfma_f32_32x32x16_bf16 v[88:103], v[64:67], a[100:103], v[88:103]
ds_read_b64_tr_b16 v[52:53], v11 offset:24640
ds_read_b64_tr_b16 v[54:55], v11 offset:25408
s_waitcnt lgkmcnt(4)
v_mfma_f32_32x32x16_bf16 v[104:119], v[68:71], a[100:103], v[104:119]
ds_read_b64_tr_b16 v[56:57], v11 offset:24704
ds_read_b64_tr_b16 v[58:59], v11 offset:25472
s_waitcnt lgkmcnt(4)
v_mfma_f32_32x32x16_bf16 v[72:87], v[48:51], a[104:107], v[72:87]
ds_read_b64_tr_b16 v[60:61], v12 offset:24576
ds_read_b64_tr_b16 v[62:63], v12 offset:25344
s_waitcnt lgkmcnt(4)
v_mfma_f32_32x32x16_bf16 v[88:103], v[52:55], a[104:107], v[88:103]
ds_read_b64_tr_b16 v[64:65], v12 offset:24640
ds_read_b64_tr_b16 v[66:67], v12 offset:25408
s_waitcnt lgkmcnt(4)
v_mfma_f32_32x32x16_bf16 v[104:119], v[56:59], a[104:107], v[104:119]
ds_read_b64_tr_b16 v[68:69], v12 offset:24704
ds_read_b64_tr_b16 v[70:71], v12 offset:25472
s_barrier
s_waitcnt lgkmcnt(4)
v_mfma_f32_32x32x16_bf16 v[72:87], v[60:63], a[108:111], v[72:87]
ds_read_b64_tr_b16 v[48:49], v9 offset:36864
ds_read_b64_tr_b16 v[50:51], v9 offset:37632
s_waitcnt lgkmcnt(4)
v_mfma_f32_32x32x16_bf16 v[88:103], v[64:67], a[108:111], v[88:103]
ds_read_b64_tr_b16 v[52:53], v9 offset:36928
ds_read_b64_tr_b16 v[54:55], v9 offset:37696
s_waitcnt lgkmcnt(4)
v_mfma_f32_32x32x16_bf16 v[104:119], v[68:71], a[108:111], v[104:119]
ds_read_b64_tr_b16 v[56:57], v9 offset:36992
ds_read_b64_tr_b16 v[58:59], v9 offset:37760
s_waitcnt lgkmcnt(4)
v_mfma_f32_32x32x16_bf16 v[72:87], v[48:51], a[112:115], v[72:87]
ds_read_b64_tr_b16 v[60:61], v10 offset:36864
ds_read_b64_tr_b16 v[62:63], v10 offset:37632
v_mfma_f32_16x16x32_bf16 v[36:39], v[32:35], v[48:51], v[36:39]
s_waitcnt lgkmcnt(4)
v_mfma_f32_32x32x16_bf16 v[88:103], v[52:55], a[112:115], v[88:103]
ds_read_b64_tr_b16 v[64:65], v10 offset:36928
ds_read_b64_tr_b16 v[66:67], v10 offset:37696
v_mfma_f32_16x16x32_bf16 v[40:43], v[32:35], v[52:55], v[40:43]
s_waitcnt lgkmcnt(4)
v_mfma_f32_32x32x16_bf16 v[104:119], v[56:59], a[112:115], v[104:119]
ds_read_b64_tr_b16 v[68:69], v10 offset:36992
ds_read_b64_tr_b16 v[70:71], v10 offset:37760
v_mfma_f32_16x16x32_bf16 v[44:47], v[32:35], v[56:59], v[44:47]
s_waitcnt lgkmcnt(4)
v_mfma_f32_32x32x16_bf16 v[72:87], v[60:63], a[116:119], v[72:87]
ds_read_b64_tr_b16 v[48:49], v11 offset:36864
ds_read_b64_tr_b16 v[50:51], v11 offset:37632
s_waitcnt lgkmcnt(4)
v_mfma_f32_32x32x16_bf16 v[88:103], v[64:67], a[116:119], v[88:103]
ds_read_b64_tr_b16 v[52:53], v11 offset:36928
ds_read_b64_tr_b16 v[54:55], v11 offset:37696
s_waitcnt lgkmcnt(4)
v_mfma_f32_32x32x16_bf16 v[104:119], v[68:71], a[116:119], v[104:119]
ds_read_b64_tr_b16 v[56:57], v11 offset:36992
ds_read_b64_tr_b16 v[58:59], v11 offset:37760
ds_write_b32 v17, v36 offset:0
ds_write_b32 v17, v40 offset:128
ds_write_b32 v17, v44 offset:256
s_waitcnt lgkmcnt(7)
v_mfma_f32_32x32x16_bf16 v[72:87], v[48:51], a[120:123], v[72:87]
ds_read_b64_tr_b16 v[60:61], v12 offset:36864
ds_read_b64_tr_b16 v[62:63], v12 offset:37632
s_waitcnt lgkmcnt(7)
v_mfma_f32_32x32x16_bf16 v[88:103], v[52:55], a[120:123], v[88:103]
ds_read_b64_tr_b16 v[64:65], v12 offset:36928
ds_read_b64_tr_b16 v[66:67], v12 offset:37696
s_waitcnt lgkmcnt(7)
v_mfma_f32_32x32x16_bf16 v[104:119], v[56:59], a[120:123], v[104:119]
ds_read_b64_tr_b16 v[68:69], v12 offset:36992
ds_read_b64_tr_b16 v[70:71], v12 offset:37760
s_waitcnt lgkmcnt(6)
s_barrier
s_waitcnt lgkmcnt(4)
v_mfma_f32_32x32x16_bf16 v[72:87], v[60:63], a[124:127], v[72:87]
s_waitcnt lgkmcnt(2)
v_mfma_f32_32x32x16_bf16 v[88:103], v[64:67], a[124:127], v[88:103]
s_waitcnt lgkmcnt(0)
v_mfma_f32_32x32x16_bf16 v[104:119], v[68:71], a[124:127], v[104:119]
ds_read_b32 v48, v18 offset:0
ds_read_b32 v49, v18 offset:384
ds_read_b32 v50, v18 offset:768
ds_read_b32 v51, v18 offset:1152
ds_read_b32 v52, v18 offset:256
ds_read_b32 v53, v18 offset:640
ds_read_b32 v54, v18 offset:1024
ds_read_b32 v55, v18 offset:1408
s_waitcnt lgkmcnt(0)
v_add_f32 v48, v48, v49
v_add_f32 v50, v50, v51
v_add_f32 v52, v52, v53
v_add_f32 v54, v54, v55
v_add_f32 v48, v48, v50
v_add_f32 v52, v52, v54
ds_write_b32 v19, v48
s_mov_b32 exec_hi, 0
ds_write_b32 v19, v52 offset:256
s_mov_b32 exec_hi, -1
s_nop 7
ds_read_b128 v[36:39], v20 offset:0
ds_read_b128 v[40:43], v20 offset:32
ds_read_b128 v[44:47], v20 offset:64
ds_read_b128 v[120:123], v20 offset:96
ds_read_b128 v[48:51], v20 offset:128
ds_read_b128 v[52:55], v20 offset:160
ds_read_b128 v[56:59], v20 offset:192
ds_read_b128 v[124:127], v20 offset:224
s_waitcnt lgkmcnt(4)
v_pk_fma_f32 v[72:73], v[36:37], v[26:27], v[72:73] op_sel_hi:[1,0,1]
v_pk_fma_f32 v[74:75], v[38:39], v[26:27], v[74:75] op_sel_hi:[1,0,1]
v_pk_fma_f32 v[76:77], v[40:41], v[26:27], v[76:77] op_sel_hi:[1,0,1]
v_pk_fma_f32 v[78:79], v[42:43], v[26:27], v[78:79] op_sel_hi:[1,0,1]
v_pk_fma_f32 v[80:81], v[44:45], v[26:27], v[80:81] op_sel_hi:[1,0,1]
v_pk_fma_f32 v[82:83], v[46:47], v[26:27], v[82:83] op_sel_hi:[1,0,1]
v_pk_fma_f32 v[84:85], v[120:121], v[26:27], v[84:85] op_sel_hi:[1,0,1]
v_pk_fma_f32 v[86:87], v[122:123], v[26:27], v[86:87] op_sel_hi:[1,0,1]
ds_read_b128 v[36:39], v20 offset:256
ds_read_b128 v[40:43], v20 offset:288
ds_read_b128 v[44:47], v20 offset:320
ds_read_b128 v[120:123], v20 offset:352
v_pk_mul_f32 v[72:73], v[72:73], v[28:29] op_sel_hi:[1,0]
v_pk_mul_f32 v[74:75], v[74:75], v[28:29] op_sel_hi:[1,0]
v_pk_mul_f32 v[76:77], v[76:77], v[28:29] op_sel_hi:[1,0]
v_pk_mul_f32 v[78:79], v[78:79], v[28:29] op_sel_hi:[1,0]
v_pk_mul_f32 v[80:81], v[80:81], v[28:29] op_sel_hi:[1,0]
v_pk_mul_f32 v[82:83], v[82:83], v[28:29] op_sel_hi:[1,0]
v_pk_mul_f32 v[84:85], v[84:85], v[28:29] op_sel_hi:[1,0]
v_pk_mul_f32 v[86:87], v[86:87], v[28:29] op_sel_hi:[1,0]
v_cvt_pk_bf16_f32 v60, v72, v73
v_cvt_pk_bf16_f32 v61, v74, v75
v_cvt_pk_bf16_f32 v62, v76, v77
v_cvt_pk_bf16_f32 v63, v78, v79
v_cvt_pk_bf16_f32 v64, v80, v81
v_cvt_pk_bf16_f32 v65, v82, v83
v_cvt_pk_bf16_f32 v66, v84, v85
v_cvt_pk_bf16_f32 v67, v86, v87
v_pk_max_i16 v60, v60, 0
v_pk_max_i16 v61, v61, 0
v_pk_max_i16 v62, v62, 0
v_pk_max_i16 v63, v63, 0
v_pk_max_i16 v64, v64, 0
v_pk_max_i16 v65, v65, 0
v_pk_max_i16 v66, v66, 0
v_pk_max_i16 v67, v67, 0
s_mul_i32 s34, s22, 3
s_add_u32 s34, s34, 0
s_cmp_ge_u32 s34, 43
s_cselect_b32 s35, 0x7ffefff0, s43
buffer_store_dwordx4 v[60:63], v8, s[16:19], s35 offen offset:0 sc1
buffer_store_dwordx4 v[64:67], v8, s[16:19], s35 offen offset:1024 sc1
s_add_u32 s43, s43, 2048
s_waitcnt lgkmcnt(4)
v_pk_fma_f32 v[88:89], v[48:49], v[26:27], v[88:89] op_sel_hi:[1,0,1]
v_pk_fma_f32 v[90:91], v[50:51], v[26:27], v[90:91] op_sel_hi:[1,0,1]
v_pk_fma_f32 v[92:93], v[52:53], v[26:27], v[92:93] op_sel_hi:[1,0,1]
v_pk_fma_f32 v[94:95], v[54:55], v[26:27], v[94:95] op_sel_hi:[1,0,1]
v_pk_fma_f32 v[96:97], v[56:57], v[26:27], v[96:97] op_sel_hi:[1,0,1]
v_pk_fma_f32 v[98:99], v[58:59], v[26:27], v[98:99] op_sel_hi:[1,0,1]
v_pk_fma_f32 v[100:101], v[124:125], v[26:27], v[100:101] op_sel_hi:[1,0,1]
v_pk_fma_f32 v[102:103], v[126:127], v[26:27], v[102:103] op_sel_hi:[1,0,1]
v_pk_mul_f32 v[88:89], v[88:89], v[28:29] op_sel_hi:[1,0]
v_pk_mul_f32 v[90:91], v[90:91], v[28:29] op_sel_hi:[1,0]
v_pk_mul_f32 v[92:93], v[92:93], v[28:29] op_sel_hi:[1,0]
v_pk_mul_f32 v[94:95], v[94:95], v[28:29] op_sel_hi:[1,0]
v_pk_mul_f32 v[96:97], v[96:97], v[28:29] op_sel_hi:[1,0]
v_pk_mul_f32 v[98:99], v[98:99], v[28:29] op_sel_hi:[1,0]
v_pk_mul_f32 v[100:101], v[100:101], v[28:29] op_sel_hi:[1,0]
v_pk_mul_f32 v[102:103], v[102:103], v[28:29] op_sel_hi:[1,0]
v_cvt_pk_bf16_f32 v60, v88, v89
v_cvt_pk_bf16_f32 v61, v90, v91
v_cvt_pk_bf16_f32 v62, v92, v93
v_cvt_pk_bf16_f32 v63, v94, v95
v_cvt_pk_bf16_f32 v64, v96, v97
v_cvt_pk_bf16_f32 v65, v98, v99
v_cvt_pk_bf16_f32 v66, v100, v101
v_cvt_pk_bf16_f32 v67, v102, v103
v_pk_max_i16 v60, v60, 0
v_pk_max_i16 v61, v61, 0
v_pk_max_i16 v62, v62, 0
v_pk_max_i16 v63, v63, 0
v_pk_max_i16 v64, v64, 0
v_pk_max_i16 v65, v65, 0
v_pk_max_i16 v66, v66, 0
v_pk_max_i16 v67, v67, 0
s_mul_i32 s34, s22, 3
s_add_u32 s34, s34, 1
s_cmp_ge_u32 s34, 43
s_cselect_b32 s35, 0x7ffefff0, s43
buffer_store_dwordx4 v[60:63], v8, s[16:19], s35 offen offset:0 sc1
buffer_store_dwordx4 v[64:67], v8, s[16:19], s35 offen offset:1024 sc1
s_add_u32 s43, s43, 2048
s_waitcnt lgkmcnt(0)
v_pk_fma_f32 v[104:105], v[36:37], v[26:27], v[104:105] op_sel_hi:[1,0,1]
v_pk_fma_f32 v[106:107], v[38:39], v[26:27], v[106:107] op_sel_hi:[1,0,1]
v_pk_fma_f32 v[108:109], v[40:41], v[26:27], v[108:109] op_sel_hi:[1,0,1]
v_pk_fma_f32 v[110:111], v[42:43], v[26:27], v[110:111] op_sel_hi:[1,0,1]
v_pk_fma_f32 v[112:113], v[44:45], v[26:27], v[112:113] op_sel_hi:[1,0,1]
v_pk_fma_f32 v[114:115], v[46:47], v[26:27], v[114:115] op_sel_hi:[1,0,1]
v_pk_fma_f32 v[116:117], v[120:121], v[26:27], v[116:117] op_sel_hi:[1,0,1]
v_pk_fma_f32 v[118:119], v[122:123], v[26:27], v[118:119] op_sel_hi:[1,0,1]
v_pk_mul_f32 v[104:105], v[104:105], v[28:29] op_sel_hi:[1,0]
v_pk_mul_f32 v[106:107], v[106:107], v[28:29] op_sel_hi:[1,0]
v_pk_mul_f32 v[108:109], v[108:109], v[28:29] op_sel_hi:[1,0]
v_pk_mul_f32 v[110:111], v[110:111], v[28:29] op_sel_hi:[1,0]
v_pk_mul_f32 v[112:113], v[112:113], v[28:29] op_sel_hi:[1,0]
v_pk_mul_f32 v[114:115], v[114:115], v[28:29] op_sel_hi:[1,0]
v_pk_mul_f32 v[116:117], v[116:117], v[28:29] op_sel_hi:[1,0]
v_pk_mul_f32 v[118:119], v[118:119], v[28:29] op_sel_hi:[1,0]
v_cvt_pk_bf16_f32 v60, v104, v105
v_cvt_pk_bf16_f32 v61, v106, v107
v_cvt_pk_bf16_f32 v62, v108, v109
v_cvt_pk_bf16_f32 v63, v110, v111
v_cvt_pk_bf16_f32 v64, v112, v113
v_cvt_pk_bf16_f32 v65, v114, v115
v_cvt_pk_bf16_f32 v66, v116, v117
v_cvt_pk_bf16_f32 v67, v118, v119
v_pk_max_i16 v60, v60, 0
v_pk_max_i16 v61, v61, 0
v_pk_max_i16 v62, v62, 0
v_pk_max_i16 v63, v63, 0
v_pk_max_i16 v64, v64, 0
v_pk_max_i16 v65, v65, 0
v_pk_max_i16 v66, v66, 0
v_pk_max_i16 v67, v67, 0
s_mul_i32 s34, s22, 3
s_add_u32 s34, s34, 2
s_cmp_ge_u32 s34, 43
s_cselect_b32 s35, 0x7ffefff0, s43
buffer_store_dwordx4 v[60:63], v8, s[16:19], s35 offen offset:0 sc1
buffer_store_dwordx4 v[64:67], v8, s[16:19], s35 offen offset:1024 sc1
s_add_u32 s43, s43, 2048
v_and_b32 v2, 31, v1
v_lshrrev_b32 v3, 5, v1
v_lshlrev_b32 v3, 2, v3
v_sub_u32 v4, v2, v3
v_mov_b32 v9, 0xf149f2ca
v_mov_b32 v5, 0
s_cmp_eq_u32 s53, 0
s_cselect_b32 s34, 0xf149f2ca, 0
v_mov_b32 v11, s34
v_cmp_le_i32 s[56:57], 0, v4
v_cmp_le_i32 s[58:59], 1, v4
s_nop 0
v_cndmask_b32 v16, v9, v5, s[56:57]
v_cndmask_b32 v17, v9, v5, s[58:59]
v_cndmask_b32 v32, v11, v9, s[56:57]
v_cndmask_b32 v33, v11, v9, s[58:59]
v_cmp_le_i32 s[56:57], 2, v4
v_cmp_le_i32 s[58:59], 3, v4
s_nop 0
v_cndmask_b32 v18, v9, v5, s[56:57]
v_cndmask_b32 v19, v9, v5, s[58:59]
v_cndmask_b32 v34, v11, v9, s[56:57]
v_cndmask_b32 v35, v11, v9, s[58:59]
v_cmp_le_i32 s[56:57], 8, v4
v_cmp_le_i32 s[58:59], 9, v4
s_nop 0
v_cndmask_b32 v20, v9, v5, s[56:57]
v_cndmask_b32 v21, v9, v5, s[58:59]
v_cndmask_b32 v36, v11, v9, s[56:57]
v_cndmask_b32 v37, v11, v9, s[58:59]
v_cmp_le_i32 s[56:57], 10, v4
v_cmp_le_i32 s[58:59], 11, v4
s_nop 0
v_cndmask_b32 v22, v9, v5, s[56:57]
v_cndmask_b32 v23, v9, v5, s[58:59]
v_cndmask_b32 v38, v11, v9, s[56:57]
v_cndmask_b32 v39, v11, v9, s[58:59]
v_cmp_le_i32 s[56:57], 16, v4
v_cmp_le_i32 s[58:59], 17, v4
s_nop 0
v_cndmask_b32 v24, v9, v5, s[56:57]
v_cndmask_b32 v25, v9, v5, s[58:59]
v_cndmask_b32 v40, v11, v9, s[56:57]
v_cndmask_b32 v41, v11, v9, s[58:59]
v_cmp_le_i32 s[56:57], 18, v4
v_cmp_le_i32 s[58:59], 19, v4
s_nop 0
v_cndmask_b32 v26, v9, v5, s[56:57]
v_cndmask_b32 v27, v9, v5, s[58:59]
v_cndmask_b32 v42, v11, v9, s[56:57]
v_cndmask_b32 v43, v11, v9, s[58:59]
v_cmp_le_i32 s[56:57], 24, v4
v_cmp_le_i32 s[58:59], 25, v4
s_nop 0
v_cndmask_b32 v28, v9, v5, s[56:57]
v_cndmask_b32 v29, v9, v5, s[58:59]
v_cndmask_b32 v44, v11, v9, s[56:57]
v_cndmask_b32 v45, v11, v9, s[58:59]
v_cmp_le_i32 s[56:57], 26, v4
v_cmp_le_i32 s[58:59], 27, v4
s_nop 0
v_cndmask_b32 v30, v9, v5, s[56:57]
v_cndmask_b32 v31, v9, v5, s[58:59]
v_cndmask_b32 v46, v11, v9, s[56:57]
v_cndmask_b32 v47, v11, v9, s[58:59]
v_mov_b32 v48, v11
v_mov_b32 v49, v11
v_mov_b32 v50, v11
v_mov_b32 v51, v11
v_mov_b32 v52, v11
v_mov_b32 v53, v11
v_mov_b32 v54, v11
v_mov_b32 v55, v11
v_mov_b32 v56, v11
v_mov_b32 v57, v11
v_mov_b32 v58, v11
v_mov_b32 v59, v11
v_mov_b32 v60, v11
v_mov_b32 v61, v11
v_mov_b32 v62, v11
v_mov_b32 v63, v11
s_lshl_b32 s34, s20, 10
s_add_u32 s35, s34, 73728
v_add_u32 v6, s35, v8
v_bfe_u32 v2, v1, 2, 2
v_lshrrev_b32 v3, 5, v1
v_lshl_add_u32 v2, v3, 2, v2
v_lshlrev_b32 v2, 5, v2
v_and_b32 v3, 1, v1
v_lshl_add_u32 v2, v3, 4, v2
v_bfe_u32 v3, v1, 1, 1
v_lshl_add_u32 v2, v3, 3, v2
s_lshl_b32 s34, s20, 10
s_add_u32 s35, s34, 90112
v_add_u32 v7, s35, v2
v_and_b32 v3, 15, v1
v_lshlrev_b32 v3, 3, v3
v_add_u32 v3, 106496, v3
v_bfe_u32 v2, v1, 4, 1
v_cmp_eq_u32 vcc, 1, v2
v_mov_b32 v2, 0x400
v_mov_b32 v4, 0
v_cndmask_b32 v7, v7, v3, vcc
v_cndmask_b32 v13, v2, v4, vcc
v_mov_b32 v12, v9
v_cmp_eq_u32 vcc, 0, v1
v_mov_b32 v2, 0x7ffffff0
v_mov_b32 v3, 0
s_nop 0
v_cndmask_b32 v14, v2, v3, vcc
v_lshrrev_b32 v2, 3, v1
v_lshlrev_b32 v2, 10, v2
v_bfe_u32 v3, v1, 4, 1
v_lshlrev_b32 v3, 2, v3
v_and_b32 v4, 7, v1
v_xor_b32 v3, v3, v4
v_lshl_add_u32 v10, v3, 4, v2
v_mov_b32 v2, 0x3f803f80
v_lshlrev_b32 v3, 2, v0
v_add_u32 v3, 106496, v3
ds_write_b32 v3, v2
s_branch Ljoin
Lloader:
s_getpc_b64 s[98:99]
Lpf_base:
s_lshl_b32 s34, s33, 2
s_add_u32 s34, s34, s38
s_min_u32 s34, s34, (Lcode_end-Lpf_first)/1024-1
s_lshl_b32 s34, s34, 10
s_sub_u32 s98, s98, Lpf_base-Lpf_first
s_subb_u32 s99, s99, 0
s_add_u32 s98, s98, s34
s_addc_u32 s99, s99, 0
global_load_dwordx4 v[76:79], v8, s[98:99]
v_lshrrev_b32 v2, 3, v1
v_lshlrev_b32 v2, 10, v2
v_and_b32 v3, 7, v1
v_lshrrev_b32 v4, 4, v1
v_xor_b32 v3, v3, v4
v_lshl_add_u32 v64, v3, 4, v2
v_xor_b32 v3, 4, v3
v_lshl_add_u32 v65, v3, 4, v2
v_add_u32 v66, 14336, v64
v_add_u32 v67, 21504, v65
v_add_u32 v65, 7168, v65
s_mov_b32 s35, 43691
s_movk_i32 s36, 3072
s_movk_i32 s37, 2752
v_mov_b32 v2, v1
v_mul_u32_u24 v3, s35, v2
v_lshrrev_b32 v3, 19, v3
v_mul_u32_u24 v4, 12, v3
v_sub_u32 v4, v2, v4
v_lshlrev_b32 v4, 4, v4
v_mad_u32_u24 v68, v3, s36, v4
v_mad_u32_u24 v71, v3, s37, v4
v_add_u32 v2, 64, v1
v_mul_u32_u24 v3, s35, v2
v_lshrrev_b32 v3, 19, v3
v_mul_u32_u24 v4, 12, v3
v_sub_u32 v4, v2, v4
v_lshlrev_b32 v4, 4, v4
v_subrev_u32 v4, 1024, v4
v_mad_u32_u24 v69, v3, s36, v4
v_mad_u32_u24 v72, v3, s37, v4
v_add_u32 v2, 128, v1
v_mul_u32_u24 v3, s35, v2
v_lshrrev_b32 v3, 19, v3
v_mul_u32_u24 v4, 12, v3
v_sub_u32 v4, v2, v4
v_lshlrev_b32 v4, 4, v4
v_subrev_u32 v4, 2048, v4
v_mad_u32_u24 v70, v3, s36, v4
v_mad_u32_u24 v73, v3, s37, v4
s_lshl_b32 s24, s39, 15
s_mul_i32 s25, s38, 49152
s_mul_i32 s26, s22, 192
s_add_u32 s25, s25, s26
s_mul_i32 s34, s38, 44032
s_add_u32 s26, s26, s34
s_mul_i32 s27, s38, 3072
s_lshl_b32 s28, s38, 12
s_add_u32 s28, s28, 73728
s_mov_b32 s29, s21
s_waitcnt lgkmcnt(0)
s_mov_b32 s4, s60
s_and_b32 s5, s61, 0xffff
s_mov_b32 s6, 2097152
s_mov_b32 s7, 0x20000
s_mov_b32 s8, s62
s_and_b32 s9, s63, 0xffff
s_mov_b32 s10, 1572864
s_mov_b32 s11, 0x20000
s_add_u32 s48, s29, 0
s_and_b32 s48, s48, 7
s_lshl_b32 s48, s48, 7
s_add_u32 m0, s28, 0
s_add_u32 s48, s48, s24
buffer_load_dwordx4 v64, s[4:7], s48 offen offset:0 lds
buffer_load_dwordx4 v65, s[4:7], s48 offen offset:1024 lds
buffer_load_dwordx4 v66, s[4:7], s48 offen offset:2048 lds
buffer_load_dwordx4 v67, s[4:7], s48 offen offset:3072 lds
s_add_u32 s49, s29, 0
s_and_b32 s49, s49, 7
s_mul_i32 s49, s49, 196608
s_add_u32 m0, s27, 0
s_add_u32 s49, s49, s25
buffer_load_dwordx4 v68, s[8:11], s49 offen offset:0 lds
buffer_load_dwordx4 v69, s[8:11], s49 offen offset:1024 lds
buffer_load_dwordx4 v70, s[8:11], s49 offen offset:2048 lds
s_mov_b32 s88, s74
s_and_b32 s89, s75, 0xffff
s_mov_b32 s90, 256
s_mov_b32 s91, 0x20000
s_lshl_b32 s51, s2, 2
s_add_u32 s51, s51, s38
s_mov_b32 s12, s68
s_and_b32 s13, s69, 0xffff
s_mov_b32 s14, 1409024
s_mov_b32 s15, 0x20000
s_mov_b32 s16, s76
s_and_b32 s17, s77, 0xffff
s_mov_b32 s18, 16777216
s_mov_b32 s19, 0x20000
s_add_u32 s48, s29, 1
s_and_b32 s48, s48, 7
s_lshl_b32 s48, s48, 7
s_add_u32 m0, s28, 16384
s_add_u32 s48, s48, s24
buffer_load_dwordx4 v64, s[4:7], s48 offen offset:0 lds
buffer_load_dwordx4 v65, s[4:7], s48 offen offset:1024 lds
buffer_load_dwordx4 v66, s[4:7], s48 offen offset:2048 lds
buffer_load_dwordx4 v67, s[4:7], s48 offen offset:3072 lds
s_add_u32 s49, s29, 1
s_and_b32 s49, s49, 7
s_mul_i32 s49, s49, 196608
s_add_u32 m0, s27, 12288
s_add_u32 s49, s49, s25
buffer_load_dwordx4 v68, s[8:11], s49 offen offset:0 lds
buffer_load_dwordx4 v69, s[8:11], s49 offen offset:1024 lds
buffer_load_dwordx4 v70, s[8:11], s49 offen offset:2048 lds
s_waitcnt vmcnt(7)
s_barrier
s_add_u32 s48, s29, 2
s_and_b32 s48, s48, 7
s_lshl_b32 s48, s48, 7
s_add_u32 m0, s28, 32768
s_add_u32 s48, s48, s24
buffer_load_dwordx4 v64, s[4:7], s48 offen offset:0 lds
buffer_load_dwordx4 v65, s[4:7], s48 offen offset:1024 lds
buffer_load_dwordx4 v66, s[4:7], s48 offen offset:2048 lds
buffer_load_dwordx4 v67, s[4:7], s48 offen offset:3072 lds
s_add_u32 s49, s29, 2
s_and_b32 s49, s49, 7
s_mul_i32 s49, s49, 196608
s_add_u32 m0, s27, 24576
s_add_u32 s49, s49, s25
buffer_load_dwordx4 v68, s[8:11], s49 offen offset:0 lds
buffer_load_dwordx4 v69, s[8:11], s49 offen offset:1024 lds
buffer_load_dwordx4 v70, s[8:11], s49 offen offset:2048 lds
s_waitcnt vmcnt(7)
s_barrier
s_add_u32 s48, s29, 3
s_and_b32 s48, s48, 7
s_lshl_b32 s48, s48, 7
s_add_u32 m0, s28, 49152
s_add_u32 s48, s48, s24
buffer_load_dwordx4 v64, s[4:7], s48 offen offset:0 lds
buffer_load_dwordx4 v65, s[4:7], s48 offen offset:1024 lds
buffer_load_dwordx4 v66, s[4:7], s48 offen offset:2048 lds
buffer_load_dwordx4 v67, s[4:7], s48 offen offset:3072 lds
s_add_u32 s49, s29, 3
s_and_b32 s49, s49, 7
s_mul_i32 s49, s49, 196608
s_add_u32 m0, s27, 36864
s_add_u32 s49, s49, s25
buffer_load_dwordx4 v68, s[8:11], s49 offen offset:0 lds
buffer_load_dwordx4 v69, s[8:11], s49 offen offset:1024 lds
buffer_load_dwordx4 v70, s[8:11], s49 offen offset:2048 lds
s_waitcnt vmcnt(7)
s_barrier
s_add_u32 s48, s29, 4
s_and_b32 s48, s48, 7
s_lshl_b32 s48, s48, 7
s_add_u32 m0, s28, 0
s_add_u32 s48, s48, s24
buffer_load_dwordx4 v64, s[4:7], s48 offen offset:0 lds
buffer_load_dwordx4 v65, s[4:7], s48 offen offset:1024 lds
buffer_load_dwordx4 v66, s[4:7], s48 offen offset:2048 lds
buffer_load_dwordx4 v67, s[4:7], s48 offen offset:3072 lds
s_add_u32 s49, s29, 4
s_and_b32 s49, s49, 7
s_mul_i32 s49, s49, 196608
s_add_u32 m0, s27, 49152
s_add_u32 s49, s49, s25
buffer_load_dwordx4 v68, s[8:11], s49 offen offset:0 lds
buffer_load_dwordx4 v69, s[8:11], s49 offen offset:1024 lds
buffer_load_dwordx4 v70, s[8:11], s49 offen offset:2048 lds
s_waitcnt vmcnt(7)
s_barrier
s_add_u32 s48, s29, 5
s_and_b32 s48, s48, 7
s_lshl_b32 s48, s48, 7
s_add_u32 m0, s28, 16384
s_add_u32 s48, s48, s24
buffer_load_dwordx4 v64, s[4:7], s48 offen offset:0 lds
buffer_load_dwordx4 v65, s[4:7], s48 offen offset:1024 lds
buffer_load_dwordx4 v66, s[4:7], s48 offen offset:2048 lds
buffer_load_dwordx4 v67, s[4:7], s48 offen offset:3072 lds
s_add_u32 s49, s29, 5
s_and_b32 s49, s49, 7
s_mul_i32 s49, s49, 196608
s_add_u32 m0, s27, 61440
s_add_u32 s49, s49, s25
buffer_load_dwordx4 v68, s[8:11], s49 offen offset:0 lds
buffer_load_dwordx4 v69, s[8:11], s49 offen offset:1024 lds
buffer_load_dwordx4 v70, s[8:11], s49 offen offset:2048 lds
s_waitcnt vmcnt(7)
s_barrier
s_add_u32 s48, s29, 6
s_and_b32 s48, s48, 7
s_lshl_b32 s48, s48, 7
s_add_u32 m0, s28, 32768
s_add_u32 s48, s48, s24
buffer_load_dwordx4 v64, s[4:7], s48 offen offset:0 lds
buffer_load_dwordx4 v65, s[4:7], s48 offen offset:1024 lds
buffer_load_dwordx4 v66, s[4:7], s48 offen offset:2048 lds
buffer_load_dwordx4 v67, s[4:7], s48 offen offset:3072 lds
s_add_u32 s49, s29, 6
s_and_b32 s49, s49, 7
s_mul_i32 s49, s49, 196608
s_add_u32 m0, s27, 0
s_add_u32 s49, s49, s25
buffer_load_dwordx4 v68, s[8:11], s49 offen offset:0 lds
buffer_load_dwordx4 v69, s[8:11], s49 offen offset:1024 lds
buffer_load_dwordx4 v70, s[8:11], s49 offen offset:2048 lds
s_add_u32 s49, s29, 7
s_and_b32 s49, s49, 7
s_mul_i32 s49, s49, 196608
s_add_u32 m0, s27, 12288
s_add_u32 s49, s49, s25
buffer_load_dwordx4 v68, s[8:11], s49 offen offset:0 lds
buffer_load_dwordx4 v69, s[8:11], s49 offen offset:1024 lds
buffer_load_dwordx4 v70, s[8:11], s49 offen offset:2048 lds
s_waitcnt vmcnt(10)
s_barrier
s_add_u32 s48, s29, 7
s_and_b32 s48, s48, 7
s_lshl_b32 s48, s48, 7
s_add_u32 m0, s28, 49152
s_add_u32 s48, s48, s24
buffer_load_dwordx4 v64, s[4:7], s48 offen offset:0 lds
buffer_load_dwordx4 v65, s[4:7], s48 offen offset:1024 lds
buffer_load_dwordx4 v66, s[4:7], s48 offen offset:2048 lds
buffer_load_dwordx4 v67, s[4:7], s48 offen offset:3072 lds
s_add_u32 s49, s29, 8
s_and_b32 s49, s49, 7
s_mul_i32 s49, s49, 176128
s_add_u32 m0, s27, 24576
s_add_u32 s49, s49, s26
buffer_load_dwordx4 v71, s[12:15], s49 offen offset:0 lds
buffer_load_dwordx4 v72, s[12:15], s49 offen offset:1024 lds
buffer_load_dwordx4 v73, s[12:15], s49 offen offset:2048 lds
s_add_u32 s49, s29, 9
s_and_b32 s49, s49, 7
s_mul_i32 s49, s49, 176128
s_add_u32 m0, s27, 36864
s_add_u32 s49, s49, s26
buffer_load_dwordx4 v71, s[12:15], s49 offen offset:0 lds
buffer_load_dwordx4 v72, s[12:15], s49 offen offset:1024 lds
buffer_load_dwordx4 v73, s[12:15], s49 offen offset:2048 lds
s_waitcnt vmcnt(13)
s_barrier
s_add_u32 s49, s29, 10
s_and_b32 s49, s49, 7
s_mul_i32 s49, s49, 176128
s_add_u32 m0, s27, 49152
s_add_u32 s49, s49, s26
buffer_load_dwordx4 v71, s[12:15], s49 offen offset:0 lds
buffer_load_dwordx4 v72, s[12:15], s49 offen offset:1024 lds
buffer_load_dwordx4 v73, s[12:15], s49 offen offset:2048 lds
v_mov_b32 v75, 0
buffer_load_dword v74, v75, s[88:91], 0 offen sc0 sc1
s_waitcnt vmcnt(10)
s_barrier
s_add_u32 s49, s29, 11
s_and_b32 s49, s49, 7
s_mul_i32 s49, s49, 176128
s_add_u32 m0, s27, 61440
s_add_u32 s49, s49, s26
buffer_load_dwordx4 v71, s[12:15], s49 offen offset:0 lds
buffer_load_dwordx4 v72, s[12:15], s49 offen offset:1024 lds
buffer_load_dwordx4 v73, s[12:15], s49 offen offset:2048 lds
s_lshl_b32 s52, s32, 2
s_and_b32 s34, s33, 3
s_add_u32 s52, s52, s34
s_lshr_b32 s53, s33, 2
s_lshl_b32 s80, s32, 2
s_lshr_b32 s34, s33, 3
s_add_u32 s80, s80, s34
s_and_b32 s81, s33, 7
s_and_b32 s82, s20, 1
s_lshr_b32 s83, s20, 1
s_lshl_b32 s84, s80, 1
s_add_u32 s84, s84, s82
s_mul_i32 s85, s84, 86
s_mul_i32 s34, s83, 22
s_add_u32 s85, s85, s34
s_lshl_b32 s85, s85, 10
s_add_u32 s85, s85, 6291456
s_lshl_b32 s86, s84, 5
s_lshl_b32 s34, s83, 3
s_add_u32 s86, s86, s34
s_lshl_b32 s86, s86, 10
s_add_u32 s86, s86, 12582912
s_mul_i32 s87, s83, 22
s_add_u32 s87, s87, s82
s_lshl_b32 s87, s87, 14
s_lshl_b32 s34, s81, 7
s_add_u32 s87, s87, s34
s_lshl_b32 s96, s83, 3
s_add_u32 s96, s96, s82
s_lshl_b32 s96, s96, 14
s_lshl_b32 s34, s81, 7
s_add_u32 s96, s96, s34
s_lshl_b32 s97, s20, 11
s_lshl_b32 s34, s53, 3
s_add_u32 s99, s34, s20
s_mov_b32 s100, s52
s_mov_b32 s101, s53
s_waitcnt vmcnt(10)
s_barrier
s_add_u32 s49, s29, 12
s_and_b32 s49, s49, 7
s_mul_i32 s49, s49, 176128
s_add_u32 m0, s27, 0
s_add_u32 s49, s49, s26
buffer_load_dwordx4 v71, s[12:15], s49 offen offset:0 lds
buffer_load_dwordx4 v72, s[12:15], s49 offen offset:1024 lds
buffer_load_dwordx4 v73, s[12:15], s49 offen offset:2048 lds
s_add_u32 s34, s38, 0
s_lshl_b32 s40, s34, 11
s_lshr_b32 s35, s34, 1
s_mul_i32 s35, s35, 22
s_and_b32 s34, s34, 1
s_add_u32 s35, s35, s34
s_lshl_b32 s35, s35, 14
s_lshl_b32 s34, s81, 7
s_add_u32 s42, s35, s34
s_add_u32 s34, s38, 4
s_lshl_b32 s41, s34, 11
s_lshr_b32 s35, s34, 1
s_mul_i32 s35, s35, 22
s_and_b32 s34, s34, 1
s_add_u32 s35, s35, s34
s_lshl_b32 s35, s35, 14
s_lshl_b32 s34, s81, 7
s_add_u32 s43, s35, s34
v_and_b32 v2, 31, v1
v_lshrrev_b32 v3, 5, v1
v_lshlrev_b32 v3, 2, v3
v_sub_u32 v4, v2, v3
v_mov_b32 v9, 0xf149f2ca
v_mov_b32 v5, 0
s_cmp_eq_u32 s53, 0
s_cselect_b32 s34, 0xf149f2ca, 0
v_mov_b32 v11, s34
v_cmp_le_i32 s[56:57], 0, v4
v_cmp_le_i32 s[58:59], 1, v4
s_nop 0
v_cndmask_b32 v16, v9, v5, s[56:57]
v_cndmask_b32 v17, v9, v5, s[58:59]
v_cndmask_b32 v32, v11, v9, s[56:57]
v_cndmask_b32 v33, v11, v9, s[58:59]
v_cmp_le_i32 s[56:57], 2, v4
v_cmp_le_i32 s[58:59], 3, v4
s_nop 0
v_cndmask_b32 v18, v9, v5, s[56:57]
v_cndmask_b32 v19, v9, v5, s[58:59]
v_cndmask_b32 v34, v11, v9, s[56:57]
v_cndmask_b32 v35, v11, v9, s[58:59]
v_cmp_le_i32 s[56:57], 8, v4
v_cmp_le_i32 s[58:59], 9, v4
s_nop 0
v_cndmask_b32 v20, v9, v5, s[56:57]
v_cndmask_b32 v21, v9, v5, s[58:59]
v_cndmask_b32 v36, v11, v9, s[56:57]
v_cndmask_b32 v37, v11, v9, s[58:59]
v_cmp_le_i32 s[56:57], 10, v4
v_cmp_le_i32 s[58:59], 11, v4
s_nop 0
v_cndmask_b32 v22, v9, v5, s[56:57]
v_cndmask_b32 v23, v9, v5, s[58:59]
v_cndmask_b32 v38, v11, v9, s[56:57]
v_cndmask_b32 v39, v11, v9, s[58:59]
v_cmp_le_i32 s[56:57], 16, v4
v_cmp_le_i32 s[58:59], 17, v4
s_nop 0
v_cndmask_b32 v24, v9, v5, s[56:57]
v_cndmask_b32 v25, v9, v5, s[58:59]
v_cndmask_b32 v40, v11, v9, s[56:57]
v_cndmask_b32 v41, v11, v9, s[58:59]
v_cmp_le_i32 s[56:57], 18, v4
v_cmp_le_i32 s[58:59], 19, v4
s_nop 0
v_cndmask_b32 v26, v9, v5, s[56:57]
v_cndmask_b32 v27, v9, v5, s[58:59]
v_cndmask_b32 v42, v11, v9, s[56:57]
v_cndmask_b32 v43, v11, v9, s[58:59]
v_cmp_le_i32 s[56:57], 24, v4
v_cmp_le_i32 s[58:59], 25, v4
s_nop 0
v_cndmask_b32 v28, v9, v5, s[56:57]
v_cndmask_b32 v29, v9, v5, s[58:59]
v_cndmask_b32 v44, v11, v9, s[56:57]
v_cndmask_b32 v45, v11, v9, s[58:59]
v_cmp_le_i32 s[56:57], 26, v4
v_cmp_le_i32 s[58:59], 27, v4
s_nop 0
v_cndmask_b32 v30, v9, v5, s[56:57]
v_cndmask_b32 v31, v9, v5, s[58:59]
v_cndmask_b32 v46, v11, v9, s[56:57]
v_cndmask_b32 v47, v11, v9, s[58:59]
v_mov_b32 v48, v11
v_mov_b32 v49, v11
v_mov_b32 v50, v11
v_mov_b32 v51, v11
v_mov_b32 v52, v11
v_mov_b32 v53, v11
v_mov_b32 v54, v11
v_mov_b32 v55, v11
v_mov_b32 v56, v11
v_mov_b32 v57, v11
v_mov_b32 v58, v11
v_mov_b32 v59, v11
v_mov_b32 v60, v11
v_mov_b32 v61, v11
v_mov_b32 v62, v11
v_mov_b32 v63, v11
s_lshl_b32 s34, s20, 10
s_add_u32 s35, s34, 73728
v_add_u32 v6, s35, v8
v_bfe_u32 v2, v1, 2, 2
v_lshrrev_b32 v3, 5, v1
v_lshl_add_u32 v2, v3, 2, v2
v_lshlrev_b32 v2, 5, v2
v_and_b32 v3, 1, v1
v_lshl_add_u32 v2, v3, 4, v2
v_bfe_u32 v3, v1, 1, 1
v_lshl_add_u32 v2, v3, 3, v2
s_lshl_b32 s34, s20, 10
s_add_u32 s35, s34, 90112
v_add_u32 v7, s35, v2
v_and_b32 v3, 15, v1
v_lshlrev_b32 v3, 3, v3
v_add_u32 v3, 106496, v3
v_bfe_u32 v2, v1, 4, 1
v_cmp_eq_u32 vcc, 1, v2
v_mov_b32 v2, 0x400
v_mov_b32 v4, 0
v_cndmask_b32 v7, v7, v3, vcc
v_cndmask_b32 v13, v2, v4, vcc
v_mov_b32 v12, v9
v_cmp_eq_u32 vcc, 0, v1
v_mov_b32 v2, 0x7ffffff0
v_mov_b32 v3, 0
s_nop 0
v_cndmask_b32 v14, v2, v3, vcc
v_lshrrev_b32 v2, 3, v1
v_lshlrev_b32 v2, 10, v2
v_bfe_u32 v3, v1, 4, 1
v_lshlrev_b32 v3, 2, v3
v_and_b32 v4, 7, v1
v_xor_b32 v3, v3, v4
v_lshl_add_u32 v10, v3, 4, v2
s_waitcnt vmcnt(10)
s_barrier
s_add_u32 s49, s29, 13
s_and_b32 s49, s49, 7
s_mul_i32 s49, s49, 176128
s_add_u32 m0, s27, 12288
s_add_u32 s49, s49, s26
buffer_load_dwordx4 v71, s[12:15], s49 offen offset:0 lds
buffer_load_dwordx4 v72, s[12:15], s49 offen offset:1024 lds
buffer_load_dwordx4 v73, s[12:15], s49 offen offset:2048 lds
s_lshl_b32 s34, s53, 1
s_sub_u32 s34, s34, 2
v_lshrrev_b32 v2, 4, v1
v_add_u32 v2, s34, v2
v_cmp_le_i32 s[54:55], 0, v2
v_max_i32 v2, 0, v2
v_and_b32 v3, 15, v1
v_lshlrev_b32 v2, 6, v2
v_lshl_add_u32 v64, v3, 2, v2
s_mul_i32 s34, s52, 43691
s_lshr_b32 s34, s34, 18
s_add_u32 s35, s52, 32
s_mul_i32 s35, s35, 43691
s_lshr_b32 s35, s35, 18
s_add_u32 s36, s52, 64
s_mul_i32 s36, s36, 43691
s_lshr_b32 s36, s36, 18
v_cmp_eq_u32 s[56:57], s34, v3
v_cmp_eq_u32 s[58:59], s35, v3
v_cmp_eq_u32 vcc, s36, v3
s_nop 2
s_or_b64 s[56:57], s[56:57], s[58:59]
s_or_b64 s[56:57], s[56:57], vcc
s_and_b64 s[54:55], s[54:55], s[56:57]
s_mov_b32 s50, 15728640
s_cmp_eq_u32 s20, 4
s_cselect_b32 s50, s50, 0x7fffeff0
v_mov_b32 v66, 162304
v_mov_b32 v3, 0
ds_write_b32 v66, v3
s_waitcnt lgkmcnt(0)
s_lshl_b32 s34, s53, 3
s_lshl_b32 s35, s38, 2
s_add_u32 s34, s34, s35
s_sub_i32 s34, s34, 8
s_max_i32 s34, s34, 0
s_lshl_b32 s34, s34, 10
s_lshl_b32 s35, s52, 16
s_add_u32 s44, s34, s35
s_lshl_b32 s47, s38, 12
s_add_u32 s47, s47, 73728
s_lshl_b32 s34, s53, 3
s_lshl_b32 s36, s38, 1
s_add_u32 s34, s34, s36
s_lshl_b32 s34, s34, 10
s_add_u32 s45, s34, s35
s_lshl_b32 s46, s38, 11
s_add_u32 s46, s46, 65536
s_mov_b32 s8, s70
s_and_b32 s9, s71, 0xffff
s_mov_b32 s10, 1409024
s_mov_b32 s11, 0x20000
s_waitcnt vmcnt(10)
s_barrier
s_add_u32 s49, s29, 14
s_and_b32 s49, s49, 7
s_mul_i32 s49, s49, 176128
s_add_u32 m0, s27, 24576
s_add_u32 s49, s49, s26
buffer_load_dwordx4 v71, s[12:15], s49 offen offset:0 lds
buffer_load_dwordx4 v72, s[12:15], s49 offen offset:1024 lds
buffer_load_dwordx4 v73, s[12:15], s49 offen offset:2048 lds
s_waitcnt vmcnt(12)
v_readfirstlane_b32 s23, v74
s_nop 3
s_cmp_eq_u32 s23, 0
s_cbranch_scc1 Ln_1_stub
Ln_1:
s_lshl_b32 s34, s21, 6
s_lshl_b32 s35, s22, 2
s_add_u32 s34, s34, s35
s_add_u32 s34, s34, 15728640
v_mov_b32 v2, 0x7ffffff0
v_mov_b32 v3, 0
s_sub_u32 s35, s20, 4
v_or_b32 v4, s35, v1
v_cmp_eq_u32 vcc, 0, v4
v_mov_b32 v5, s23
s_nop 0
v_cndmask_b32 v2, v2, v3, vcc
buffer_store_dword v5, v2, s[16:19], s34 offen sc1
s_waitcnt vmcnt(10)
s_barrier
s_add_u32 s49, s29, 15
s_and_b32 s49, s49, 7
s_mul_i32 s49, s49, 176128
s_add_u32 m0, s27, 36864
s_add_u32 s49, s49, s26
buffer_load_dwordx4 v71, s[12:15], s49 offen offset:0 lds
buffer_load_dwordx4 v72, s[12:15], s49 offen offset:1024 lds
buffer_load_dwordx4 v73, s[12:15], s49 offen offset:2048 lds
s_waitcnt vmcnt(10)
s_barrier
s_mov_b32 s92, s70
s_and_b32 s93, s71, 0xffff
s_mov_b32 s94, 1409024
s_mov_b32 s95, 0x20000
s_mul_i32 s34, s51, 1376
buffer_load_dwordx4 v[76:79], v8, s[92:95], s34 offen
buffer_load_dwordx4 v[76:79], v8, s[92:95], s34 offen offset:352
s_mov_b32 s92, s64
s_and_b32 s93, s65, 0xffff
s_mov_b32 s94, 524288
s_mov_b32 s95, 0x20000
s_lshl_b32 s34, s51, 9
buffer_load_dwordx4 v[76:79], v8, s[92:95], s34 offen
s_mov_b32 s12, s64
s_and_b32 s13, s65, 0xffff
s_mov_b32 s14, 524288
s_mov_b32 s15, 0x20000
s_add_u32 m0, s40, 140288
s_add_u32 s98, s42, 0
buffer_load_dwordx4 v10, s[8:11], s98 offen lds
s_add_u32 m0, s40, 141312
s_add_u32 s98, s42, 8192
buffer_load_dwordx4 v10, s[8:11], s98 offen lds
s_add_u32 m0, s41, 140288
s_add_u32 s98, s43, 0
buffer_load_dwordx4 v10, s[8:11], s98 offen lds
s_add_u32 m0, s41, 141312
s_add_u32 s98, s43, 8192
buffer_load_dwordx4 v10, s[8:11], s98 offen lds
s_waitcnt vmcnt(14)
s_barrier
s_add_u32 m0, s40, 107520
s_add_u32 s98, s42, 32768
buffer_load_dwordx4 v10, s[8:11], s98 offen lds
s_add_u32 m0, s40, 108544
s_add_u32 s98, s42, 40960
buffer_load_dwordx4 v10, s[8:11], s98 offen lds
s_add_u32 m0, s41, 107520
s_add_u32 s98, s43, 32768
buffer_load_dwordx4 v10, s[8:11], s98 offen lds
s_add_u32 m0, s41, 108544
s_add_u32 s98, s43, 40960
buffer_load_dwordx4 v10, s[8:11], s98 offen lds
s_waitcnt vmcnt(15)
s_barrier
buffer_load_dword v65, v64, s[16:19], s50 offen sc1
s_add_u32 m0, s40, 123904
s_add_u32 s98, s42, 65536
buffer_load_dwordx4 v10, s[8:11], s98 offen lds
s_add_u32 m0, s40, 124928
s_add_u32 s98, s42, 73728
buffer_load_dwordx4 v10, s[8:11], s98 offen lds
s_add_u32 m0, s41, 123904
s_add_u32 s98, s43, 65536
buffer_load_dwordx4 v10, s[8:11], s98 offen lds
s_add_u32 m0, s41, 124928
s_add_u32 s98, s43, 73728
buffer_load_dwordx4 v10, s[8:11], s98 offen lds
s_waitcnt vmcnt(16)
s_barrier
s_waitcnt vmcnt(4)
s_cmp_lg_u32 s20, 4
s_cbranch_scc1 Lno_2
v_cmp_ne_u32 vcc, s23, v65
s_nop 2
s_and_b64 s[56:57], vcc, s[54:55]
s_cbranch_scc1 Lno_2
v_mov_b32 v3, 1
ds_write_b32 v66, v3
s_waitcnt lgkmcnt(0)
Lno_2:
s_barrier
ds_read_b32 v3, v66
s_waitcnt lgkmcnt(0)
v_readfirstlane_b32 s34, v3
s_nop 3
s_cmp_lg_u32 s34, 0
s_cbranch_scc1 Lgo_4
s_cmp_lg_u32 s20, 4
s_cbranch_scc1 Lsp_3
buffer_load_dword v65, v64, s[16:19], s50 offen sc1
s_waitcnt vmcnt(0)
v_cmp_ne_u32 vcc, s23, v65
s_nop 2
s_and_b64 s[56:57], vcc, s[54:55]
s_cbranch_scc1 Lp_5_stub
Lp_5:
v_mov_b32 v3, 1
ds_write_b32 v66, v3
s_branch Lgo_4
Lsp_3:
s_mov_b32 s58, 0
Lsp_3_l:
s_sleep 1
ds_read_b32 v3, v66
s_waitcnt lgkmcnt(0)
v_readfirstlane_b32 s34, v3
s_add_u32 s58, s58, 1
s_cmp_gt_u32 s58, 0x100000
s_cbranch_scc1 Lgo_4
s_cmp_eq_u32 s34, 0
s_cbranch_scc1 Lsp_3_l
Lgo_4:
s_mov_b32 m0, s47
s_add_u32 s28, s44, 2097152
buffer_load_dwordx4 v8, s[16:19], s28 offen offset:0 sc1 lds
buffer_load_dwordx4 v8, s[16:19], s28 offen offset:1024 sc1 lds
buffer_load_dwordx4 v8, s[16:19], s28 offen offset:2048 sc1 lds
buffer_load_dwordx4 v8, s[16:19], s28 offen offset:3072 sc1 lds
s_mov_b32 m0, s46
s_nop 0
buffer_load_dwordx4 v8, s[16:19], s45 offen offset:0 sc1 lds
buffer_load_dwordx4 v8, s[16:19], s45 offen offset:1024 sc1 lds
s_add_u32 m0, s47, 16384
s_add_u32 s28, s44, 4194304
buffer_load_dwordx4 v8, s[16:19], s28 offen offset:0 sc1 lds
buffer_load_dwordx4 v8, s[16:19], s28 offen offset:1024 sc1 lds
buffer_load_dwordx4 v8, s[16:19], s28 offen offset:2048 sc1 lds
buffer_load_dwordx4 v8, s[16:19], s28 offen offset:3072 sc1 lds
s_waitcnt vmcnt(4)
Ljoin:
s_waitcnt lgkmcnt(0)
s_sub_u32 s88, 8, s20
s_cmp_eq_u32 s53, 0
s_cselect_b32 s88, s88, 0
s_lshl_b32 s51, s39, 6
s_lshl_b32 s34, s22, 2
s_add_u32 s51, s51, s34
s_add_u32 s51, s51, 15732736
s_cmp_ge_u32 s20, 4
s_cselect_b32 s51, 0x7fffeff0, s51
s_lshl_b32 s34, s84, 6
s_add_u32 s89, s34, 15732736
v_and_b32 v2, 15, v1
v_lshlrev_b32 v5, 2, v2
s_barrier
s_lshl_b32 s34, s20, 10
s_add_u32 s34, s34, 65536
v_add_u32 v2, s34, v8
ds_read_b128 a[116:119], v2
ds_read_b128 v[64:67], v2
s_lshl_b32 s34, s20, 11
s_add_u32 s34, s34, 73728
v_add_u32 v3, s34, v8
ds_read_b128 v[68:71], v3
ds_read_b128 v[72:75], v3 offset:1024
s_waitcnt lgkmcnt(0)
v_dot2_f32_bf16 v76, v64, v64, 0
v_dot2_f32_bf16 v77, v68, v68, 0
v_dot2_f32_bf16 v78, v72, v72, 0
v_dot2_f32_bf16 v76, v65, v65, v76
v_dot2_f32_bf16 v77, v69, v69, v77
v_dot2_f32_bf16 v78, v73, v73, v78
v_dot2_f32_bf16 v76, v66, v66, v76
v_dot2_f32_bf16 v77, v70, v70, v77
v_dot2_f32_bf16 v78, v74, v74, v78
v_dot2_f32_bf16 v76, v67, v67, v76
v_dot2_f32_bf16 v77, v71, v71, v77
v_dot2_f32_bf16 v78, v75, v75, v78
s_nop 2
v_mov_b32 v79, v76
v_mov_b32 v80, v77
v_mov_b32 v81, v78
s_nop 0
v_permlane32_swap_b32 v76, v79
v_permlane32_swap_b32 v77, v80
v_permlane32_swap_b32 v78, v81
v_add_f32 v76, v76, v79
v_add_f32 v77, v77, v80
v_add_f32 v78, v78, v81
s_nop 0
v_max_f32_dpp v76, v76, v76 row_shr:1 row_mask:0xf bank_mask:0xf bound_ctrl:0
v_max_f32_dpp v77, v77, v77 row_shr:1 row_mask:0xf bank_mask:0xf bound_ctrl:0
v_max_f32_dpp v78, v78, v78 row_shr:1 row_mask:0xf bank_mask:0xf bound_ctrl:0
s_nop 0
v_max_f32_dpp v76, v76, v76 row_shr:2 row_mask:0xf bank_mask:0xf bound_ctrl:0
v_max_f32_dpp v77, v77, v77 row_shr:2 row_mask:0xf bank_mask:0xf bound_ctrl:0
v_max_f32_dpp v78, v78, v78 row_shr:2 row_mask:0xf bank_mask:0xf bound_ctrl:0
s_nop 0
v_max_f32_dpp v76, v76, v76 row_shr:4 row_mask:0xf bank_mask:0xf bound_ctrl:0
v_max_f32_dpp v77, v77, v77 row_shr:4 row_mask:0xf bank_mask:0xf bound_ctrl:0
v_max_f32_dpp v78, v78, v78 row_shr:4 row_mask:0xf bank_mask:0xf bound_ctrl:0
s_nop 0
v_max_f32_dpp v76, v76, v76 row_shr:8 row_mask:0xf bank_mask:0xf bound_ctrl:0
v_max_f32_dpp v77, v77, v77 row_shr:8 row_mask:0xf bank_mask:0xf bound_ctrl:0
v_max_f32_dpp v78, v78, v78 row_shr:8 row_mask:0xf bank_mask:0xf bound_ctrl:0
s_nop 0
v_max_f32_dpp v76, v76, v76 row_bcast:15 row_mask:0xa bank_mask:0xf
v_max_f32_dpp v77, v77, v77 row_bcast:15 row_mask:0xa bank_mask:0xf
v_max_f32_dpp v78, v78, v78 row_bcast:15 row_mask:0xa bank_mask:0xf
s_nop 0
v_readlane_b32 s40, v76, 31
v_readlane_b32 s41, v77, 31
v_readlane_b32 s42, v78, 31
s_lshl_b32 s34, s20, 3
s_add_u32 s34, s34, 162368
v_mov_b32 v2, s34
v_mov_b32 v76, s41
v_mov_b32 v77, s42
ds_write_b64 v2, v[76:77]
s_waitcnt lgkmcnt(0)
s_waitcnt vmcnt(0)
v_mov_b32 v4, s23
buffer_store_dword v4, v14, s[16:19], s51 offen sc1
s_barrier
v_min_u32 v2, 8, v1
v_add_u32 v2, s20, v2
v_lshlrev_b32 v2, 2, v2
v_add_u32 v2, 162368, v2
ds_read_b32 v76, v2
s_waitcnt lgkmcnt(0)
s_nop 1
v_max_f32_dpp v76, v76, v76 row_shr:1 row_mask:0xf bank_mask:0xf bound_ctrl:0
s_nop 1
v_max_f32_dpp v76, v76, v76 row_shr:2 row_mask:0xf bank_mask:0xf bound_ctrl:0
s_nop 1
v_max_f32_dpp v76, v76, v76 row_shr:4 row_mask:0xf bank_mask:0xf bound_ctrl:0
s_nop 1
v_max_f32_dpp v76, v76, v76 row_shr:8 row_mask:0xf bank_mask:0xf bound_ctrl:0
v_mov_b32 v12, 0
v_mul_f32 v76, s40, v76
v_mov_b32 v77, 0x45610000
s_nop 0
v_cmp_lt_f32 vcc, v77, v76
s_nop 2
s_cmp_eq_u64 vcc, 0
s_cbranch_scc1 Lfast_8
v_mov_b32 v12, v9
ds_read_b128 a[88:91], v6 offset:0
ds_read_b128 a[92:95], v6 offset:1024
s_waitcnt lgkmcnt(1)
v_mfma_f32_32x32x16_bf16 v[64:79], a[88:91], a[116:119], v[32:47]
ds_read_b128 a[96:99], v6 offset:2048
s_cmp_eq_u32 s88, 1
s_cbranch_scc1 Lt_9_stub
Lt_9:
s_waitcnt lgkmcnt(1)
v_mfma_f32_32x32x16_bf16 v[80:95], a[92:95], a[116:119], v[48:63]
ds_read_b128 a[88:91], v6 offset:3072
s_cmp_eq_u32 s88, 2
s_cbranch_scc1 Lt_10_stub
Lt_10:
s_waitcnt lgkmcnt(1)
v_mfma_f32_32x32x16_bf16 v[96:111], a[96:99], a[116:119], v[48:63]
ds_read_b128 a[92:95], v6 offset:4096
s_nop 7
s_nop 3
v_max3_f32 v12, v64, v65, v12
v_max3_f32 v12, v66, v67, v12
v_max3_f32 v12, v68, v69, v12
v_max3_f32 v12, v70, v71, v12
v_max3_f32 v12, v72, v73, v12
v_max3_f32 v12, v74, v75, v12
v_max3_f32 v12, v76, v77, v12
v_max3_f32 v12, v78, v79, v12
s_cmp_eq_u32 s88, 3
s_cbranch_scc1 Lt_11_stub
Lt_11:
s_waitcnt lgkmcnt(1)
v_mfma_f32_32x32x16_bf16 v[64:79], a[88:91], a[116:119], v[48:63]
ds_read_b128 a[96:99], v6 offset:5120
v_max3_f32 v12, v80, v81, v12
v_max3_f32 v12, v82, v83, v12
v_max3_f32 v12, v84, v85, v12
v_max3_f32 v12, v86, v87, v12
v_max3_f32 v12, v88, v89, v12
v_max3_f32 v12, v90, v91, v12
v_max3_f32 v12, v92, v93, v12
v_max3_f32 v12, v94, v95, v12
s_cmp_eq_u32 s88, 4
s_cbranch_scc1 Lt_12_stub
Lt_12:
s_waitcnt lgkmcnt(1)
v_mfma_f32_32x32x16_bf16 v[80:95], a[92:95], a[116:119], v[48:63]
ds_read_b128 a[88:91], v6 offset:6144
v_max3_f32 v12, v96, v97, v12
v_max3_f32 v12, v98, v99, v12
v_max3_f32 v12, v100, v101, v12
v_max3_f32 v12, v102, v103, v12
v_max3_f32 v12, v104, v105, v12
v_max3_f32 v12, v106, v107, v12
v_max3_f32 v12, v108, v109, v12
v_max3_f32 v12, v110, v111, v12
s_cmp_eq_u32 s88, 5
s_cbranch_scc1 Lt_13_stub
Lt_13:
s_waitcnt lgkmcnt(1)
v_mfma_f32_32x32x16_bf16 v[96:111], a[96:99], a[116:119], v[48:63]
ds_read_b128 a[92:95], v6 offset:7168
v_max3_f32 v12, v64, v65, v12
v_max3_f32 v12, v66, v67, v12
v_max3_f32 v12, v68, v69, v12
v_max3_f32 v12, v70, v71, v12
v_max3_f32 v12, v72, v73, v12
v_max3_f32 v12, v74, v75, v12
v_max3_f32 v12, v76, v77, v12
v_max3_f32 v12, v78, v79, v12
s_cmp_eq_u32 s88, 6
s_cbranch_scc1 Lt_14_stub
Lt_14:
s_waitcnt lgkmcnt(1)
v_mfma_f32_32x32x16_bf16 v[64:79], a[88:91], a[116:119], v[48:63]
ds_read_b128 a[96:99], v6 offset:8192
v_max3_f32 v12, v80, v81, v12
v_max3_f32 v12, v82, v83, v12
v_max3_f32 v12, v84, v85, v12
v_max3_f32 v12, v86, v87, v12
v_max3_f32 v12, v88, v89, v12
v_max3_f32 v12, v90, v91, v12
v_max3_f32 v12, v92, v93, v12
v_max3_f32 v12, v94, v95, v12
s_cmp_eq_u32 s88, 7
s_cbranch_scc1 Lt_15_stub
Lt_15:
s_waitcnt lgkmcnt(1)
v_mfma_f32_32x32x16_bf16 v[80:95], a[92:95], a[116:119], v[48:63]
v_max3_f32 v12, v96, v97, v12
v_max3_f32 v12, v98, v99, v12
v_max3_f32 v12, v100, v101, v12
v_max3_f32 v12, v102, v103, v12
v_max3_f32 v12, v104, v105, v12
v_max3_f32 v12, v106, v107, v12
v_max3_f32 v12, v108, v109, v12
v_max3_f32 v12, v110, v111, v12
s_cmp_eq_u32 s88, 8
s_cbranch_scc1 Lt_16_stub
Lt_16:
s_waitcnt lgkmcnt(0)
v_mfma_f32_32x32x16_bf16 v[96:111], a[96:99], a[116:119], v[16:31]
v_max3_f32 v12, v64, v65, v12
v_max3_f32 v12, v66, v67, v12
v_max3_f32 v12, v68, v69, v12
v_max3_f32 v12, v70, v71, v12
v_max3_f32 v12, v72, v73, v12
v_max3_f32 v12, v74, v75, v12
v_max3_f32 v12, v76, v77, v12
v_max3_f32 v12, v78, v79, v12
s_nop 7
s_nop 3
v_max3_f32 v12, v80, v81, v12
v_max3_f32 v12, v82, v83, v12
v_max3_f32 v12, v84, v85, v12
v_max3_f32 v12, v86, v87, v12
v_max3_f32 v12, v88, v89, v12
v_max3_f32 v12, v90, v91, v12
v_max3_f32 v12, v92, v93, v12
v_max3_f32 v12, v94, v95, v12
s_nop 7
s_nop 3
v_max3_f32 v12, v96, v97, v12
v_max3_f32 v12, v98, v99, v12
v_max3_f32 v12, v100, v101, v12
v_max3_f32 v12, v102, v103, v12
v_max3_f32 v12, v104, v105, v12
v_max3_f32 v12, v106, v107, v12
v_max3_f32 v12, v108, v109, v12
v_max3_f32 v12, v110, v111, v12
v_mov_b32 v2, v12
s_nop 1
v_permlane32_swap_b32 v12, v2
v_max_f32 v12, v12, v2
v_sub_f32 v12, 0, v12
s_cmp_eq_u32 s101, 0
s_cselect_b64 vcc, -1, 0
v_cndmask_b32 v2, v12, v9, vcc
v_mov_b32 v48, v2
v_mov_b32 v49, v2
v_mov_b32 v50, v2
v_mov_b32 v51, v2
v_mov_b32 v52, v2
v_mov_b32 v53, v2
v_mov_b32 v54, v2
v_mov_b32 v55, v2
v_mov_b32 v56, v2
v_mov_b32 v57, v2
v_mov_b32 v58, v2
v_mov_b32 v59, v2
v_mov_b32 v60, v2
v_mov_b32 v61, v2
v_mov_b32 v62, v2
v_mov_b32 v63, v2
v_add_f32 v32, v32, v12
v_add_f32 v33, v33, v12
v_add_f32 v34, v34, v12
v_add_f32 v35, v35, v12
v_add_f32 v36, v36, v12
v_add_f32 v37, v37, v12
v_add_f32 v38, v38, v12
v_add_f32 v39, v39, v12
v_add_f32 v40, v40, v12
v_add_f32 v41, v41, v12
v_add_f32 v42, v42, v12
v_add_f32 v43, v43, v12
v_add_f32 v44, v44, v12
v_add_f32 v45, v45, v12
v_add_f32 v46, v46, v12
v_add_f32 v47, v47, v12
v_add_f32 v16, v16, v12
v_add_f32 v17, v17, v12
v_add_f32 v18, v18, v12
v_add_f32 v19, v19, v12
v_add_f32 v20, v20, v12
v_add_f32 v21, v21, v12
v_add_f32 v22, v22, v12
v_add_f32 v23, v23, v12
v_add_f32 v24, v24, v12
v_add_f32 v25, v25, v12
v_add_f32 v26, v26, v12
v_add_f32 v27, v27, v12
v_add_f32 v28, v28, v12
v_add_f32 v29, v29, v12
v_add_f32 v30, v30, v12
v_add_f32 v31, v31, v12
s_waitcnt lgkmcnt(0)
Lfast_8:
s_waitcnt lgkmcnt(0)
ds_read_b128 a[88:91], v6 offset:0
ds_read_b128 a[92:95], v6 offset:1024
v_mov_b32 v2, v7
ds_read_b64_tr_b16 a[100:101], v2 offset:0
ds_read_b64_tr_b16 a[102:103], v2 offset:256
ds_read_b64_tr_b16 a[104:105], v2 offset:512
ds_read_b64_tr_b16 a[106:107], v2 offset:768
s_waitcnt lgkmcnt(5)
v_mfma_f32_32x32x16_bf16 v[64:79], a[88:91], a[116:119], v[32:47]
ds_read_b128 a[96:99], v6 offset:2048
s_nop 7
s_nop 3
s_cmp_eq_u32 s88, 1
s_cbranch_scc1 Lt_17_stub
Lt_17:
s_waitcnt lgkmcnt(5)
v_mfma_f32_32x32x16_bf16 v[80:95], a[92:95], a[116:119], v[48:63]
ds_read_b128 a[88:91], v6 offset:3072
v_exp_f32 v64, v64
v_exp_f32 v65, v65
v_exp_f32 v66, v66
v_exp_f32 v67, v67
v_exp_f32 v68, v68
v_exp_f32 v69, v69
v_exp_f32 v70, v70
v_exp_f32 v71, v71
s_add_u32 m0, s97, 0
s_add_u32 s98, s87, 98304
buffer_load_dwordx4 v10, s[8:11], s98 offen lds
v_mad_u32_u24 v2, v13, 1, v7
ds_read_b64_tr_b16 a[108:109], v2 offset:0
ds_read_b64_tr_b16 a[110:111], v2 offset:256
ds_read_b64_tr_b16 a[112:113], v2 offset:512
ds_read_b64_tr_b16 a[114:115], v2 offset:768
v_exp_f32 v72, v72
v_exp_f32 v73, v73
s_add_u32 m0, s97, 1024
s_add_u32 s98, s87, 106496
buffer_load_dwordx4 v10, s[8:11], s98 offen lds
v_exp_f32 v74, v74
v_exp_f32 v75, v75
s_add_u32 m0, s97, 16384
s_add_u32 s98, s87, 131072
buffer_load_dwordx4 v10, s[8:11], s98 offen lds
v_exp_f32 v76, v76
v_exp_f32 v77, v77
s_add_u32 m0, s97, 17408
s_add_u32 s98, s87, 139264
buffer_load_dwordx4 v10, s[8:11], s98 offen lds
v_exp_f32 v78, v78
v_exp_f32 v79, v79
s_add_u32 m0, s97, 32768
s_add_u32 s98, s87, 163840
buffer_load_dwordx4 v10, s[8:11], s98 offen lds
v_cvt_pk_bf16_f32 v112, v64, v65
v_cvt_pk_bf16_f32 v113, v66, v67
v_cvt_pk_bf16_f32 v114, v68, v69
v_cvt_pk_bf16_f32 v115, v70, v71
s_add_u32 m0, s97, 33792
s_add_u32 s98, s87, 172032
buffer_load_dwordx4 v10, s[8:11], s98 offen lds
v_cvt_pk_bf16_f32 v116, v72, v73
v_cvt_pk_bf16_f32 v117, v74, v75
v_cvt_pk_bf16_f32 v118, v76, v77
v_cvt_pk_bf16_f32 v119, v78, v79
s_add_u32 m0, s97, 49152
s_add_u32 s98, s87, 196608
buffer_load_dwordx4 v10, s[8:11], s98 offen lds
s_cmp_eq_u32 s88, 2
s_cbranch_scc1 Lt_18_stub
Lt_18:
s_waitcnt lgkmcnt(5)
v_mfma_f32_32x32x16_bf16 v[64:79], a[96:99], a[116:119], v[48:63]
ds_read_b128 a[92:95], v6 offset:4096
v_exp_f32 v80, v80
v_exp_f32 v81, v81
v_exp_f32 v82, v82
v_exp_f32 v83, v83
v_mfma_f32_32x32x16_bf16 v[96:111], a[100:103], v[112:115], 0
v_exp_f32 v84, v84
v_exp_f32 v85, v85
v_exp_f32 v86, v86
v_exp_f32 v87, v87
s_add_u32 m0, s97, 50176
s_add_u32 s98, s87, 204800
buffer_load_dwordx4 v10, s[8:11], s98 offen lds
v_mfma_f32_32x32x16_bf16 v[96:111], a[104:107], v[116:119], v[96:111]
v_mad_u32_u24 v2, v13, 2, v7
ds_read_b64_tr_b16 a[100:101], v2 offset:0
ds_read_b64_tr_b16 a[102:103], v2 offset:256
ds_read_b64_tr_b16 a[104:105], v2 offset:512
ds_read_b64_tr_b16 a[106:107], v2 offset:768
v_exp_f32 v88, v88
v_exp_f32 v89, v89
v_exp_f32 v90, v90
v_exp_f32 v91, v91
v_exp_f32 v92, v92
v_exp_f32 v93, v93
v_exp_f32 v94, v94
v_exp_f32 v95, v95
v_cvt_pk_bf16_f32 v120, v80, v81
v_cvt_pk_bf16_f32 v121, v82, v83
v_cvt_pk_bf16_f32 v122, v84, v85
v_cvt_pk_bf16_f32 v123, v86, v87
v_cvt_pk_bf16_f32 v124, v88, v89
v_cvt_pk_bf16_f32 v125, v90, v91
v_cvt_pk_bf16_f32 v126, v92, v93
v_cvt_pk_bf16_f32 v127, v94, v95
buffer_load_dword v3, v5, s[16:19], s89 offen sc1
s_cmp_eq_u32 s88, 3
s_cbranch_scc1 Lt_19_stub
Lt_19:
s_waitcnt lgkmcnt(9)
v_mfma_f32_32x32x16_bf16 v[80:95], a[88:91], a[116:119], v[48:63]
ds_read_b128 a[96:99], v6 offset:5120
v_exp_f32 v64, v64
v_exp_f32 v65, v65
v_exp_f32 v66, v66
v_exp_f32 v67, v67
s_waitcnt lgkmcnt(6)
v_mfma_f32_32x32x16_bf16 v[96:111], a[108:111], v[120:123], v[96:111]
v_exp_f32 v68, v68
v_exp_f32 v69, v69
v_exp_f32 v70, v70
v_exp_f32 v71, v71
v_mfma_f32_32x32x16_bf16 v[96:111], a[112:115], v[124:127], v[96:111]
v_mad_u32_u24 v2, v13, 3, v7
ds_read_b64_tr_b16 a[108:109], v2 offset:0
ds_read_b64_tr_b16 a[110:111], v2 offset:256
ds_read_b64_tr_b16 a[112:113], v2 offset:512
ds_read_b64_tr_b16 a[114:115], v2 offset:768
v_exp_f32 v72, v72
v_exp_f32 v73, v73
v_exp_f32 v74, v74
v_exp_f32 v75, v75
v_exp_f32 v76, v76
v_exp_f32 v77, v77
v_exp_f32 v78, v78
v_exp_f32 v79, v79
v_cvt_pk_bf16_f32 v112, v64, v65
v_cvt_pk_bf16_f32 v113, v66, v67
v_cvt_pk_bf16_f32 v114, v68, v69
v_cvt_pk_bf16_f32 v115, v70, v71
v_cvt_pk_bf16_f32 v116, v72, v73
v_cvt_pk_bf16_f32 v117, v74, v75
v_cvt_pk_bf16_f32 v118, v76, v77
v_cvt_pk_bf16_f32 v119, v78, v79
s_cmp_eq_u32 s88, 4
s_cbranch_scc1 Lt_20_stub
Lt_20:
s_waitcnt lgkmcnt(9)
v_mfma_f32_32x32x16_bf16 v[64:79], a[92:95], a[116:119], v[48:63]
ds_read_b128 a[88:91], v6 offset:6144
v_exp_f32 v80, v80
v_exp_f32 v81, v81
v_exp_f32 v82, v82
v_exp_f32 v83, v83
s_waitcnt lgkmcnt(6)
v_mfma_f32_32x32x16_bf16 v[96:111], a[100:103], v[112:115], v[96:111]
v_exp_f32 v84, v84
v_exp_f32 v85, v85
v_exp_f32 v86, v86
v_exp_f32 v87, v87
v_mfma_f32_32x32x16_bf16 v[96:111], a[104:107], v[116:119], v[96:111]
v_mad_u32_u24 v2, v13, 4, v7
ds_read_b64_tr_b16 a[100:101], v2 offset:0
ds_read_b64_tr_b16 a[102:103], v2 offset:256
ds_read_b64_tr_b16 a[104:105], v2 offset:512
ds_read_b64_tr_b16 a[106:107], v2 offset:768
v_exp_f32 v88, v88
v_exp_f32 v89, v89
v_exp_f32 v90, v90
v_exp_f32 v91, v91
v_exp_f32 v92, v92
v_exp_f32 v93, v93
v_exp_f32 v94, v94
v_exp_f32 v95, v95
v_cvt_pk_bf16_f32 v120, v80, v81
v_cvt_pk_bf16_f32 v121, v82, v83
v_cvt_pk_bf16_f32 v122, v84, v85
v_cvt_pk_bf16_f32 v123, v86, v87
v_cvt_pk_bf16_f32 v124, v88, v89
v_cvt_pk_bf16_f32 v125, v90, v91
v_cvt_pk_bf16_f32 v126, v92, v93
v_cvt_pk_bf16_f32 v127, v94, v95
s_waitcnt vmcnt(0)
s_mov_b32 exec_hi, 0
s_mov_b32 exec_lo, 0xffff
v_cmp_ne_u32 vcc, s23, v3
s_nop 2
s_and_b64 s[56:57], vcc, exec
s_cbranch_scc1 Lp_21_stub
Lp_21:
s_mov_b64 exec, -1
s_cmp_eq_u32 s88, 5
s_cbranch_scc1 Lt_22_stub
Lt_22:
s_waitcnt lgkmcnt(9)
v_mfma_f32_32x32x16_bf16 v[80:95], a[96:99], a[116:119], v[48:63]
ds_read_b128 a[92:95], v6 offset:7168
v_exp_f32 v64, v64
v_exp_f32 v65, v65
v_exp_f32 v66, v66
v_exp_f32 v67, v67
s_waitcnt lgkmcnt(6)
v_mfma_f32_32x32x16_bf16 v[96:111], a[108:111], v[120:123], v[96:111]
v_exp_f32 v68, v68
v_exp_f32 v69, v69
v_exp_f32 v70, v70
v_exp_f32 v71, v71
buffer_load_dwordx4 a[0:3], v8, s[16:19], s85 offen offset:0 sc1
v_mfma_f32_32x32x16_bf16 v[96:111], a[112:115], v[124:127], v[96:111]
v_mad_u32_u24 v2, v13, 5, v7
ds_read_b64_tr_b16 a[108:109], v2 offset:0
ds_read_b64_tr_b16 a[110:111], v2 offset:256
ds_read_b64_tr_b16 a[112:113], v2 offset:512
ds_read_b64_tr_b16 a[114:115], v2 offset:768
v_exp_f32 v72, v72
v_exp_f32 v73, v73
buffer_load_dwordx4 a[4:7], v8, s[16:19], s85 offen offset:1024 sc1
v_exp_f32 v74, v74
v_exp_f32 v75, v75
buffer_load_dwordx4 a[8:11], v8, s[16:19], s85 offen offset:2048 sc1
v_exp_f32 v76, v76
v_exp_f32 v77, v77
buffer_load_dwordx4 a[12:15], v8, s[16:19], s85 offen offset:3072 sc1
v_exp_f32 v78, v78
v_exp_f32 v79, v79
s_add_u32 s85, s85, 4096
buffer_load_dwordx4 a[16:19], v8, s[16:19], s85 offen offset:0 sc1
v_cvt_pk_bf16_f32 v112, v64, v65
v_cvt_pk_bf16_f32 v113, v66, v67
v_cvt_pk_bf16_f32 v114, v68, v69
v_cvt_pk_bf16_f32 v115, v70, v71
buffer_load_dwordx4 a[20:23], v8, s[16:19], s85 offen offset:1024 sc1
v_cvt_pk_bf16_f32 v116, v72, v73
v_cvt_pk_bf16_f32 v117, v74, v75
v_cvt_pk_bf16_f32 v118, v76, v77
v_cvt_pk_bf16_f32 v119, v78, v79
buffer_load_dwordx4 a[24:27], v8, s[16:19], s85 offen offset:2048 sc1
s_cmp_eq_u32 s88, 6
s_cbranch_scc1 Lt_23_stub
Lt_23:
s_waitcnt lgkmcnt(9)
v_mfma_f32_32x32x16_bf16 v[64:79], a[88:91], a[116:119], v[48:63]
ds_read_b128 a[96:99], v6 offset:8192
v_exp_f32 v80, v80
v_exp_f32 v81, v81
v_exp_f32 v82, v82
v_exp_f32 v83, v83
s_waitcnt lgkmcnt(6)
v_mfma_f32_32x32x16_bf16 v[96:111], a[100:103], v[112:115], v[96:111]
v_exp_f32 v84, v84
v_exp_f32 v85, v85
v_exp_f32 v86, v86
v_exp_f32 v87, v87
buffer_load_dwordx4 a[28:31], v8, s[16:19], s85 offen offset:3072 sc1
v_mfma_f32_32x32x16_bf16 v[96:111], a[104:107], v[116:119], v[96:111]
v_mad_u32_u24 v2, v13, 6, v7
ds_read_b64_tr_b16 a[100:101], v2 offset:0
ds_read_b64_tr_b16 a[102:103], v2 offset:256
ds_read_b64_tr_b16 a[104:105], v2 offset:512
ds_read_b64_tr_b16 a[106:107], v2 offset:768
v_exp_f32 v88, v88
v_exp_f32 v89, v89
s_add_u32 s85, s85, 4096
buffer_load_dwordx4 a[32:35], v8, s[16:19], s85 offen offset:0 sc1
v_exp_f32 v90, v90
v_exp_f32 v91, v91
buffer_load_dwordx4 a[36:39], v8, s[16:19], s85 offen offset:1024 sc1
v_exp_f32 v92, v92
v_exp_f32 v93, v93
buffer_load_dwordx4 a[40:43], v8, s[16:19], s85 offen offset:2048 sc1
v_exp_f32 v94, v94
v_exp_f32 v95, v95
buffer_load_dwordx4 a[44:47], v8, s[16:19], s85 offen offset:3072 sc1
v_cvt_pk_bf16_f32 v120, v80, v81
v_cvt_pk_bf16_f32 v121, v82, v83
v_cvt_pk_bf16_f32 v122, v84, v85
v_cvt_pk_bf16_f32 v123, v86, v87
s_add_u32 s85, s85, 4096
buffer_load_dwordx4 a[48:51], v8, s[16:19], s85 offen offset:0 sc1
v_cvt_pk_bf16_f32 v124, v88, v89
v_cvt_pk_bf16_f32 v125, v90, v91
v_cvt_pk_bf16_f32 v126, v92, v93
v_cvt_pk_bf16_f32 v127, v94, v95
buffer_load_dwordx4 a[52:55], v8, s[16:19], s85 offen offset:1024 sc1
s_cmp_eq_u32 s88, 7
s_cbranch_scc1 Lt_24_stub
Lt_24:
s_waitcnt lgkmcnt(9)
v_mfma_f32_32x32x16_bf16 v[80:95], a[92:95], a[116:119], v[48:63]
v_exp_f32 v64, v64
v_exp_f32 v65, v65
v_exp_f32 v66, v66
v_exp_f32 v67, v67
s_waitcnt lgkmcnt(5)
v_mfma_f32_32x32x16_bf16 v[96:111], a[108:111], v[120:123], v[96:111]
v_exp_f32 v68, v68
v_exp_f32 v69, v69
v_exp_f32 v70, v70
v_exp_f32 v71, v71
buffer_load_dwordx4 a[56:59], v8, s[16:19], s85 offen offset:2048 sc1
v_mfma_f32_32x32x16_bf16 v[96:111], a[112:115], v[124:127], v[96:111]
v_mad_u32_u24 v2, v13, 7, v7
ds_read_b64_tr_b16 a[108:109], v2 offset:0
ds_read_b64_tr_b16 a[110:111], v2 offset:256
ds_read_b64_tr_b16 a[112:113], v2 offset:512
ds_read_b64_tr_b16 a[114:115], v2 offset:768
v_exp_f32 v72, v72
v_exp_f32 v73, v73
buffer_load_dwordx4 a[60:63], v8, s[16:19], s85 offen offset:3072 sc1
v_exp_f32 v74, v74
v_exp_f32 v75, v75
s_add_u32 s85, s85, 4096
buffer_load_dwordx4 a[64:67], v8, s[16:19], s85 offen offset:0 sc1
v_exp_f32 v76, v76
v_exp_f32 v77, v77
buffer_load_dwordx4 a[68:71], v8, s[16:19], s85 offen offset:1024 sc1
v_exp_f32 v78, v78
v_exp_f32 v79, v79
buffer_load_dwordx4 a[72:75], v8, s[16:19], s85 offen offset:2048 sc1
v_cvt_pk_bf16_f32 v112, v64, v65
v_cvt_pk_bf16_f32 v113, v66, v67
v_cvt_pk_bf16_f32 v114, v68, v69
v_cvt_pk_bf16_f32 v115, v70, v71
buffer_load_dwordx4 a[76:79], v8, s[16:19], s85 offen offset:3072 sc1
v_cvt_pk_bf16_f32 v116, v72, v73
v_cvt_pk_bf16_f32 v117, v74, v75
v_cvt_pk_bf16_f32 v118, v76, v77
v_cvt_pk_bf16_f32 v119, v78, v79
s_mul_i32 s34, s83, 22
s_add_u32 s34, s34, 20
s_min_u32 s34, s34, 85
s_mul_i32 s35, s84, 86
s_add_u32 s34, s34, s35
s_lshl_b32 s34, s34, 10
s_add_u32 s34, s34, 6291456
buffer_load_dwordx4 a[80:83], v8, s[16:19], s34 offen sc1
s_cmp_eq_u32 s88, 8
s_cbranch_scc1 Lt_25_stub
Lt_25:
s_waitcnt lgkmcnt(8)
v_mfma_f32_32x32x16_bf16 v[64:79], a[96:99], a[116:119], v[16:31]
v_exp_f32 v80, v80
v_exp_f32 v81, v81
v_exp_f32 v82, v82
v_exp_f32 v83, v83
s_waitcnt lgkmcnt(4)
v_mfma_f32_32x32x16_bf16 v[96:111], a[100:103], v[112:115], v[96:111]
v_exp_f32 v84, v84
v_exp_f32 v85, v85
v_exp_f32 v86, v86
v_exp_f32 v87, v87
s_mul_i32 s34, s83, 22
s_add_u32 s34, s34, 21
s_min_u32 s34, s34, 85
s_mul_i32 s35, s84, 86
s_add_u32 s34, s34, s35
s_lshl_b32 s34, s34, 10
s_add_u32 s34, s34, 6291456
buffer_load_dwordx4 a[84:87], v8, s[16:19], s34 offen sc1
v_mfma_f32_32x32x16_bf16 v[96:111], a[104:107], v[116:119], v[96:111]
v_mad_u32_u24 v2, v13, 8, v7
ds_read_b64_tr_b16 a[100:101], v2 offset:0
ds_read_b64_tr_b16 a[102:103], v2 offset:256
ds_read_b64_tr_b16 a[104:105], v2 offset:512
ds_read_b64_tr_b16 a[106:107], v2 offset:768
v_exp_f32 v88, v88
v_exp_f32 v89, v89
v_exp_f32 v90, v90
v_exp_f32 v91, v91
v_exp_f32 v92, v92
v_exp_f32 v93, v93
v_exp_f32 v94, v94
v_exp_f32 v95, v95
v_cvt_pk_bf16_f32 v120, v80, v81
v_cvt_pk_bf16_f32 v121, v82, v83
v_cvt_pk_bf16_f32 v122, v84, v85
v_cvt_pk_bf16_f32 v123, v86, v87
v_cvt_pk_bf16_f32 v124, v88, v89
v_cvt_pk_bf16_f32 v125, v90, v91
v_cvt_pk_bf16_f32 v126, v92, v93
v_cvt_pk_bf16_f32 v127, v94, v95
v_exp_f32 v64, v64
v_exp_f32 v65, v65
v_exp_f32 v66, v66
v_exp_f32 v67, v67
s_waitcnt lgkmcnt(4)
v_mfma_f32_32x32x16_bf16 v[96:111], a[108:111], v[120:123], v[96:111]
v_exp_f32 v68, v68
v_exp_f32 v69, v69
v_exp_f32 v70, v70
v_exp_f32 v71, v71
v_mfma_f32_32x32x16_bf16 v[96:111], a[112:115], v[124:127], v[96:111]
v_exp_f32 v72, v72
v_exp_f32 v73, v73
v_exp_f32 v74, v74
v_exp_f32 v75, v75
v_exp_f32 v76, v76
v_exp_f32 v77, v77
v_exp_f32 v78, v78
v_exp_f32 v79, v79
v_cvt_pk_bf16_f32 v112, v64, v65
v_cvt_pk_bf16_f32 v113, v66, v67
v_cvt_pk_bf16_f32 v114, v68, v69
v_cvt_pk_bf16_f32 v115, v70, v71
v_cvt_pk_bf16_f32 v116, v72, v73
v_cvt_pk_bf16_f32 v117, v74, v75
v_cvt_pk_bf16_f32 v118, v76, v77
v_cvt_pk_bf16_f32 v119, v78, v79
s_nop 1
s_waitcnt lgkmcnt(0)
v_mfma_f32_32x32x16_bf16 v[96:111], a[100:103], v[112:115], v[96:111]
v_mfma_f32_32x32x16_bf16 v[96:111], a[104:107], v[116:119], v[96:111]
s_lshl_b32 s58, s99, 5
s_add_u32 s58, s58, s100
s_lshl_b32 s58, s58, 10
s_add_u32 s58, s58, 12582912
v_lshrrev_b32 v2, 5, v1
v_bfe_u32 v3, v1, 2, 2
v_lshl_add_u32 v2, v2, 2, v3
v_lshlrev_b32 v2, 7, v2
v_bfe_u32 v4, v1, 4, 1
v_lshlrev_b32 v4, 5, v4
v_and_b32 v5, 3, v1
v_lshl_add_u32 v4, v5, 3, v4
v_add_u32 v2, v2, v4
s_lshl_b32 s34, s83, 12
v_add_u32 v2, s34, v2
v_bfe_u32 v3, v1, 3, 1
v_lshlrev_b32 v3, 6, v3
v_add_u32 v16, v2, v3
v_xor_b32 v3, 64, v3
v_add_u32 v17, v2, v3
v_add_u32 v18, 65536, v16
v_add_u32 v19, 65536, v17
v_add_u32 v20, 0x20000, v16
v_add_u32 v21, 0x20000, v17
v_rcp_f32 v2, v104
s_nop 0
v_mul_f32 v96, v96, v2
v_mul_f32 v97, v97, v2
v_mul_f32 v98, v98, v2
v_mul_f32 v99, v99, v2
v_mul_f32 v100, v100, v2
v_mul_f32 v101, v101, v2
v_mul_f32 v102, v102, v2
v_mul_f32 v103, v103, v2
v_cvt_pk_bf16_f32 v80, v96, v97
v_cvt_pk_bf16_f32 v81, v98, v99
v_cvt_pk_bf16_f32 v82, v100, v101
v_cvt_pk_bf16_f32 v83, v102, v103
buffer_store_dwordx4 v[80:83], v8, s[16:19], s58 offen sc1
s_mov_b32 s92, s72
s_and_b32 s93, s73, 0xffff
s_mov_b32 s94, 2097152
s_mov_b32 s95, 0x20000
v_and_b32 v2, 31, v1
v_lshlrev_b32 v2, 10, v2
v_lshrrev_b32 v3, 5, v1
v_lshl_add_u32 v22, v3, 3, v2
s_lshl_b32 s37, s84, 15
s_lshl_b32 s34, s81, 7
s_add_u32 s37, s37, s34
s_lshl_b32 s34, s83, 5
s_add_u32 s37, s37, s34
s_nop 7
ds_read_b64_tr_b16 v[32:33], v20 offset:9216
ds_read_b64_tr_b16 v[34:35], v20 offset:10240
ds_read_b64_tr_b16 v[36:37], v21 offset:9216
ds_read_b64_tr_b16 v[38:39], v21 offset:10240
ds_read_b64_tr_b16 v[40:41], v20 offset:11264
ds_read_b64_tr_b16 v[42:43], v20 offset:12288
ds_read_b64_tr_b16 v[44:45], v21 offset:11264
ds_read_b64_tr_b16 v[46:47], v21 offset:12288
ds_read_b64_tr_b16 v[48:49], v18 offset:41984
ds_read_b64_tr_b16 v[50:51], v18 offset:43008
ds_read_b64_tr_b16 v[52:53], v19 offset:41984
ds_read_b64_tr_b16 v[54:55], v19 offset:43008
ds_read_b64_tr_b16 v[56:57], v18 offset:44032
ds_read_b64_tr_b16 v[58:59], v18 offset:45056
ds_read_b64_tr_b16 v[60:61], v19 offset:44032
ds_read_b64_tr_b16 v[62:63], v19 offset:45056
s_lshl_b32 s58, s84, 7
s_add_u32 s89, s58, 15745024
v_and_b32 v2, 31, v1
v_lshlrev_b32 v5, 2, v2
s_waitcnt vmcnt(22)
s_waitcnt lgkmcnt(14)
v_mfma_f32_32x32x16_bf16 v[96:111], v[32:35], a[0:3], 0
ds_read_b64_tr_b16 v[64:65], v18 offset:58368
ds_read_b64_tr_b16 v[66:67], v18 offset:59392
s_waitcnt lgkmcnt(14)
v_mfma_f32_32x32x16_bf16 v[112:127], v[36:39], a[0:3], 0
ds_read_b64_tr_b16 v[68:69], v19 offset:58368
ds_read_b64_tr_b16 v[70:71], v19 offset:59392
s_waitcnt vmcnt(0)
s_lshl_b32 s58, s99, 7
s_lshl_b32 s59, s100, 2
s_add_u32 s58, s58, s59
s_add_u32 s58, s58, 15745024
v_mov_b32 v4, s23
buffer_store_dword v4, v14, s[16:19], s58 offen sc1
s_waitcnt lgkmcnt(14)
v_mfma_f32_32x32x16_bf16 v[96:111], v[40:43], a[4:7], v[96:111]
ds_read_b64_tr_b16 v[32:33], v18 offset:60416
ds_read_b64_tr_b16 v[34:35], v18 offset:61440
s_waitcnt lgkmcnt(14)
v_mfma_f32_32x32x16_bf16 v[112:127], v[44:47], a[4:7], v[112:127]
ds_read_b64_tr_b16 v[36:37], v19 offset:60416
ds_read_b64_tr_b16 v[38:39], v19 offset:61440
s_barrier
s_waitcnt lgkmcnt(14)
v_mfma_f32_32x32x16_bf16 v[96:111], v[48:51], a[8:11], v[96:111]
ds_read_b64_tr_b16 v[40:41], v16 offset:0
ds_read_b64_tr_b16 v[42:43], v16 offset:1024
s_add_u32 m0, s97, 73728
s_add_u32 s98, s87, 229376
buffer_load_dwordx4 v10, s[8:11], s98 offen lds
s_waitcnt lgkmcnt(14)
v_mfma_f32_32x32x16_bf16 v[112:127], v[52:55], a[8:11], v[112:127]
ds_read_b64_tr_b16 v[44:45], v17 offset:0
ds_read_b64_tr_b16 v[46:47], v17 offset:1024
s_add_u32 m0, s97, 74752
s_add_u32 s98, s87, 237568
buffer_load_dwordx4 v10, s[8:11], s98 offen lds
s_waitcnt lgkmcnt(14)
v_mfma_f32_32x32x16_bf16 v[96:111], v[56:59], a[12:15], v[96:111]
ds_read_b64_tr_b16 v[48:49], v16 offset:2048
ds_read_b64_tr_b16 v[50:51], v16 offset:3072
s_add_u32 m0, s97, 90112
s_add_u32 s98, s87, 262144
buffer_load_dwordx4 v10, s[8:11], s98 offen lds
s_waitcnt lgkmcnt(14)
v_mfma_f32_32x32x16_bf16 v[112:127], v[60:63], a[12:15], v[112:127]
ds_read_b64_tr_b16 v[52:53], v17 offset:2048
ds_read_b64_tr_b16 v[54:55], v17 offset:3072
s_add_u32 m0, s97, 91136
s_add_u32 s98, s87, 270336
buffer_load_dwordx4 v10, s[8:11], s98 offen lds
s_barrier
s_waitcnt lgkmcnt(14)
v_mfma_f32_32x32x16_bf16 v[96:111], v[64:67], a[16:19], v[96:111]
ds_read_b64_tr_b16 v[56:57], v16 offset:16384
ds_read_b64_tr_b16 v[58:59], v16 offset:17408
s_add_u32 m0, s97, 140288
s_add_u32 s98, s87, 294912
buffer_load_dwordx4 v10, s[8:11], s98 offen lds
s_waitcnt lgkmcnt(14)
v_mfma_f32_32x32x16_bf16 v[112:127], v[68:71], a[16:19], v[112:127]
ds_read_b64_tr_b16 v[60:61], v17 offset:16384
ds_read_b64_tr_b16 v[62:63], v17 offset:17408
s_add_u32 m0, s97, 141312
s_add_u32 s98, s87, 303104
buffer_load_dwordx4 v10, s[8:11], s98 offen lds
s_waitcnt lgkmcnt(14)
v_mfma_f32_32x32x16_bf16 v[96:111], v[32:35], a[20:23], v[96:111]
ds_read_b64_tr_b16 v[64:65], v16 offset:18432
ds_read_b64_tr_b16 v[66:67], v16 offset:19456
s_add_u32 m0, s97, 107520
s_add_u32 s98, s87, 327680
buffer_load_dwordx4 v10, s[8:11], s98 offen lds
s_waitcnt lgkmcnt(14)
v_mfma_f32_32x32x16_bf16 v[112:127], v[36:39], a[20:23], v[112:127]
ds_read_b64_tr_b16 v[68:69], v17 offset:18432
ds_read_b64_tr_b16 v[70:71], v17 offset:19456
s_add_u32 m0, s97, 108544
s_add_u32 s98, s87, 335872
buffer_load_dwordx4 v10, s[8:11], s98 offen lds
s_barrier
s_waitcnt lgkmcnt(14)
v_mfma_f32_32x32x16_bf16 v[96:111], v[40:43], a[24:27], v[96:111]
ds_read_b64_tr_b16 v[32:33], v16 offset:32768
ds_read_b64_tr_b16 v[34:35], v16 offset:33792
s_add_u32 m0, s97, 123904
s_add_u32 s98, s96, 0
buffer_load_dwordx4 v10, s[12:15], s98 offen lds
s_waitcnt lgkmcnt(14)
v_mfma_f32_32x32x16_bf16 v[112:127], v[44:47], a[24:27], v[112:127]
ds_read_b64_tr_b16 v[36:37], v17 offset:32768
ds_read_b64_tr_b16 v[38:39], v17 offset:33792
s_add_u32 m0, s97, 124928
s_add_u32 s98, s96, 8192
buffer_load_dwordx4 v10, s[12:15], s98 offen lds
s_waitcnt lgkmcnt(14)
v_mfma_f32_32x32x16_bf16 v[96:111], v[48:51], a[28:31], v[96:111]
ds_read_b64_tr_b16 v[40:41], v16 offset:34816
ds_read_b64_tr_b16 v[42:43], v16 offset:35840
s_waitcnt lgkmcnt(14)
v_mfma_f32_32x32x16_bf16 v[112:127], v[52:55], a[28:31], v[112:127]
ds_read_b64_tr_b16 v[44:45], v17 offset:34816
ds_read_b64_tr_b16 v[46:47], v17 offset:35840
s_barrier
s_waitcnt lgkmcnt(14)
v_mfma_f32_32x32x16_bf16 v[96:111], v[56:59], a[32:35], v[96:111]
ds_read_b64_tr_b16 v[48:49], v16 offset:49152
ds_read_b64_tr_b16 v[50:51], v16 offset:50176
s_add_u32 m0, s97, 0
s_add_u32 s98, s96, 32768
buffer_load_dwordx4 v10, s[12:15], s98 offen lds
s_waitcnt lgkmcnt(14)
v_mfma_f32_32x32x16_bf16 v[112:127], v[60:63], a[32:35], v[112:127]
ds_read_b64_tr_b16 v[52:53], v17 offset:49152
ds_read_b64_tr_b16 v[54:55], v17 offset:50176
s_add_u32 m0, s97, 1024
s_add_u32 s98, s96, 40960
buffer_load_dwordx4 v10, s[12:15], s98 offen lds
buffer_load_dword v3, v5, s[16:19], s89 offen sc1
s_waitcnt lgkmcnt(14)
v_mfma_f32_32x32x16_bf16 v[96:111], v[64:67], a[36:39], v[96:111]
ds_read_b64_tr_b16 v[56:57], v16 offset:51200
ds_read_b64_tr_b16 v[58:59], v16 offset:52224
s_waitcnt lgkmcnt(14)
v_mfma_f32_32x32x16_bf16 v[112:127], v[68:71], a[36:39], v[112:127]
ds_read_b64_tr_b16 v[60:61], v17 offset:51200
ds_read_b64_tr_b16 v[62:63], v17 offset:52224
s_waitcnt vmcnt(11)
s_barrier
s_waitcnt lgkmcnt(14)
v_mfma_f32_32x32x16_bf16 v[96:111], v[32:35], a[40:43], v[96:111]
ds_read_b64_tr_b16 v[64:65], v18 offset:8192
ds_read_b64_tr_b16 v[66:67], v18 offset:9216
s_add_u32 m0, s97, 16384
s_add_u32 s98, s96, 65536
buffer_load_dwordx4 v10, s[12:15], s98 offen lds
s_waitcnt lgkmcnt(14)
v_mfma_f32_32x32x16_bf16 v[112:127], v[36:39], a[40:43], v[112:127]
ds_read_b64_tr_b16 v[68:69], v19 offset:8192
ds_read_b64_tr_b16 v[70:71], v19 offset:9216
s_add_u32 m0, s97, 17408
s_add_u32 s98, s96, 73728
buffer_load_dwordx4 v10, s[12:15], s98 offen lds
s_waitcnt lgkmcnt(14)
v_mfma_f32_32x32x16_bf16 v[96:111], v[40:43], a[44:47], v[96:111]
ds_read_b64_tr_b16 v[32:33], v18 offset:10240
ds_read_b64_tr_b16 v[34:35], v18 offset:11264
s_waitcnt lgkmcnt(14)
v_mfma_f32_32x32x16_bf16 v[112:127], v[44:47], a[44:47], v[112:127]
ds_read_b64_tr_b16 v[36:37], v19 offset:10240
ds_read_b64_tr_b16 v[38:39], v19 offset:11264
s_waitcnt vmcnt(11)
s_barrier
s_waitcnt vmcnt(2)
v_cmp_ne_u32 vcc, s23, v3
s_nop 2
s_and_b64 s[56:57], vcc, exec
s_cbranch_scc1 Lp_26_stub
Lp_26:
s_waitcnt lgkmcnt(14)
v_mfma_f32_32x32x16_bf16 v[96:111], v[48:51], a[48:51], v[96:111]
ds_read_b64_tr_b16 v[40:41], v18 offset:24576
ds_read_b64_tr_b16 v[42:43], v18 offset:25600
s_add_u32 m0, s97, 32768
s_add_u32 s98, s96, 98304
buffer_load_dwordx4 v10, s[12:15], s98 offen lds
s_waitcnt lgkmcnt(14)
v_mfma_f32_32x32x16_bf16 v[112:127], v[52:55], a[48:51], v[112:127]
ds_read_b64_tr_b16 v[44:45], v19 offset:24576
ds_read_b64_tr_b16 v[46:47], v19 offset:25600
s_add_u32 m0, s97, 33792
s_add_u32 s98, s96, 106496
buffer_load_dwordx4 v10, s[12:15], s98 offen lds
s_waitcnt lgkmcnt(14)
v_mfma_f32_32x32x16_bf16 v[96:111], v[56:59], a[52:55], v[96:111]
ds_read_b64_tr_b16 v[48:49], v18 offset:26624
ds_read_b64_tr_b16 v[50:51], v18 offset:27648
buffer_load_dwordx4 a[88:91], v8, s[16:19], s86 offen offset:0 sc1
s_waitcnt lgkmcnt(14)
v_mfma_f32_32x32x16_bf16 v[112:127], v[60:63], a[52:55], v[112:127]
ds_read_b64_tr_b16 v[52:53], v19 offset:26624
ds_read_b64_tr_b16 v[54:55], v19 offset:27648
buffer_load_dwordx4 a[92:95], v8, s[16:19], s86 offen offset:1024 sc1
s_barrier
s_waitcnt lgkmcnt(14)
v_mfma_f32_32x32x16_bf16 v[96:111], v[64:67], a[56:59], v[96:111]
ds_read_b64_tr_b16 v[56:57], v20 offset:9216
ds_read_b64_tr_b16 v[58:59], v20 offset:10240
buffer_load_dwordx4 a[96:99], v8, s[16:19], s86 offen offset:2048 sc1
s_waitcnt lgkmcnt(14)
v_mfma_f32_32x32x16_bf16 v[112:127], v[68:71], a[56:59], v[112:127]
ds_read_b64_tr_b16 v[60:61], v21 offset:9216
ds_read_b64_tr_b16 v[62:63], v21 offset:10240
buffer_load_dwordx4 a[100:103], v8, s[16:19], s86 offen offset:3072 sc1
s_waitcnt lgkmcnt(14)
v_mfma_f32_32x32x16_bf16 v[96:111], v[32:35], a[60:63], v[96:111]
ds_read_b64_tr_b16 v[64:65], v20 offset:11264
ds_read_b64_tr_b16 v[66:67], v20 offset:12288
s_add_u32 s86, s86, 4096
buffer_load_dwordx4 a[104:107], v8, s[16:19], s86 offen offset:0 sc1
s_waitcnt lgkmcnt(14)
v_mfma_f32_32x32x16_bf16 v[112:127], v[36:39], a[60:63], v[112:127]
ds_read_b64_tr_b16 v[68:69], v21 offset:11264
ds_read_b64_tr_b16 v[70:71], v21 offset:12288
buffer_load_dwordx4 a[108:111], v8, s[16:19], s86 offen offset:1024 sc1
s_barrier
s_waitcnt lgkmcnt(14)
v_mfma_f32_32x32x16_bf16 v[96:111], v[40:43], a[64:67], v[96:111]
ds_read_b64_tr_b16 v[32:33], v18 offset:41984
ds_read_b64_tr_b16 v[34:35], v18 offset:43008
buffer_load_dwordx4 a[112:115], v8, s[16:19], s86 offen offset:2048 sc1
s_waitcnt lgkmcnt(14)
v_mfma_f32_32x32x16_bf16 v[112:127], v[44:47], a[64:67], v[112:127]
ds_read_b64_tr_b16 v[36:37], v19 offset:41984
ds_read_b64_tr_b16 v[38:39], v19 offset:43008
buffer_load_dwordx4 a[116:119], v8, s[16:19], s86 offen offset:3072 sc1
s_waitcnt lgkmcnt(14)
v_mfma_f32_32x32x16_bf16 v[96:111], v[48:51], a[68:71], v[96:111]
ds_read_b64_tr_b16 v[40:41], v18 offset:44032
ds_read_b64_tr_b16 v[42:43], v18 offset:45056
s_waitcnt lgkmcnt(14)
v_mfma_f32_32x32x16_bf16 v[112:127], v[52:55], a[68:71], v[112:127]
ds_read_b64_tr_b16 v[44:45], v19 offset:44032
ds_read_b64_tr_b16 v[46:47], v19 offset:45056
s_barrier
s_waitcnt lgkmcnt(14)
v_mfma_f32_32x32x16_bf16 v[96:111], v[56:59], a[72:75], v[96:111]
ds_read_b64_tr_b16 v[48:49], v18 offset:58368
ds_read_b64_tr_b16 v[50:51], v18 offset:59392
s_waitcnt lgkmcnt(14)
v_mfma_f32_32x32x16_bf16 v[112:127], v[60:63], a[72:75], v[112:127]
ds_read_b64_tr_b16 v[52:53], v19 offset:58368
ds_read_b64_tr_b16 v[54:55], v19 offset:59392
s_waitcnt lgkmcnt(14)
v_mfma_f32_32x32x16_bf16 v[96:111], v[64:67], a[76:79], v[96:111]
ds_read_b64_tr_b16 v[56:57], v18 offset:60416
ds_read_b64_tr_b16 v[58:59], v18 offset:61440
s_waitcnt lgkmcnt(14)
v_mfma_f32_32x32x16_bf16 v[112:127], v[68:71], a[76:79], v[112:127]
ds_read_b64_tr_b16 v[60:61], v19 offset:60416
ds_read_b64_tr_b16 v[62:63], v19 offset:61440
s_barrier
buffer_load_dwordx2 v[24:25], v22, s[4:7], s37 offen offset:0
buffer_load_dwordx2 v[26:27], v22, s[4:7], s37 offen offset:16
s_waitcnt lgkmcnt(14)
v_mfma_f32_32x32x16_bf16 v[96:111], v[32:35], a[80:83], v[96:111]
ds_read_b64_tr_b16 v[64:65], v16 offset:0
ds_read_b64_tr_b16 v[66:67], v16 offset:1024
s_waitcnt lgkmcnt(14)
v_mfma_f32_32x32x16_bf16 v[112:127], v[36:39], a[80:83], v[112:127]
ds_read_b64_tr_b16 v[68:69], v17 offset:0
ds_read_b64_tr_b16 v[70:71], v17 offset:1024
s_waitcnt lgkmcnt(14)
v_mfma_f32_32x32x16_bf16 v[96:111], v[40:43], a[84:87], v[96:111]
ds_read_b64_tr_b16 v[32:33], v16 offset:2048
ds_read_b64_tr_b16 v[34:35], v16 offset:3072
s_waitcnt lgkmcnt(14)
v_mfma_f32_32x32x16_bf16 v[112:127], v[44:47], a[84:87], v[112:127]
ds_read_b64_tr_b16 v[36:37], v17 offset:2048
ds_read_b64_tr_b16 v[38:39], v17 offset:3072
s_waitcnt vmcnt(12)
s_barrier
s_waitcnt vmcnt(9)
s_waitcnt lgkmcnt(14)
v_mfma_f32_32x32x16_bf16 v[96:111], v[48:51], a[88:91], v[96:111]
ds_read_b64_tr_b16 v[40:41], v16 offset:16384
ds_read_b64_tr_b16 v[42:43], v16 offset:17408
s_waitcnt lgkmcnt(14)
v_mfma_f32_32x32x16_bf16 v[112:127], v[52:55], a[88:91], v[112:127]
ds_read_b64_tr_b16 v[44:45], v17 offset:16384
ds_read_b64_tr_b16 v[46:47], v17 offset:17408
s_waitcnt vmcnt(8)
s_waitcnt lgkmcnt(14)
v_mfma_f32_32x32x16_bf16 v[96:111], v[56:59], a[92:95], v[96:111]
ds_read_b64_tr_b16 v[48:49], v16 offset:18432
ds_read_b64_tr_b16 v[50:51], v16 offset:19456
s_waitcnt lgkmcnt(14)
v_mfma_f32_32x32x16_bf16 v[112:127], v[60:63], a[92:95], v[112:127]
ds_read_b64_tr_b16 v[52:53], v17 offset:18432
ds_read_b64_tr_b16 v[54:55], v17 offset:19456
s_barrier
s_waitcnt vmcnt(7)
s_waitcnt lgkmcnt(14)
v_mfma_f32_32x32x16_bf16 v[96:111], v[64:67], a[96:99], v[96:111]
ds_read_b64_tr_b16 v[56:57], v16 offset:32768
ds_read_b64_tr_b16 v[58:59], v16 offset:33792
s_waitcnt lgkmcnt(14)
v_mfma_f32_32x32x16_bf16 v[112:127], v[68:71], a[96:99], v[112:127]
ds_read_b64_tr_b16 v[60:61], v17 offset:32768
ds_read_b64_tr_b16 v[62:63], v17 offset:33792
s_waitcnt vmcnt(6)
s_waitcnt lgkmcnt(14)
v_mfma_f32_32x32x16_bf16 v[96:111], v[32:35], a[100:103], v[96:111]
ds_read_b64_tr_b16 v[64:65], v16 offset:34816
ds_read_b64_tr_b16 v[66:67], v16 offset:35840
s_waitcnt lgkmcnt(14)
v_mfma_f32_32x32x16_bf16 v[112:127], v[36:39], a[100:103], v[112:127]
ds_read_b64_tr_b16 v[68:69], v17 offset:34816
ds_read_b64_tr_b16 v[70:71], v17 offset:35840
s_waitcnt vmcnt(5)
s_waitcnt lgkmcnt(14)
v_mfma_f32_32x32x16_bf16 v[96:111], v[40:43], a[104:107], v[96:111]
s_waitcnt lgkmcnt(12)
v_mfma_f32_32x32x16_bf16 v[112:127], v[44:47], a[104:107], v[112:127]
s_waitcnt vmcnt(4)
s_waitcnt lgkmcnt(10)
v_mfma_f32_32x32x16_bf16 v[96:111], v[48:51], a[108:111], v[96:111]
s_waitcnt lgkmcnt(8)
v_mfma_f32_32x32x16_bf16 v[112:127], v[52:55], a[108:111], v[112:127]
s_waitcnt vmcnt(3)
s_waitcnt lgkmcnt(6)
v_mfma_f32_32x32x16_bf16 v[96:111], v[56:59], a[112:115], v[96:111]
s_waitcnt lgkmcnt(4)
v_mfma_f32_32x32x16_bf16 v[112:127], v[60:63], a[112:115], v[112:127]
s_waitcnt vmcnt(2)
s_waitcnt lgkmcnt(2)
v_mfma_f32_32x32x16_bf16 v[96:111], v[64:67], a[116:119], v[96:111]
s_waitcnt lgkmcnt(0)
v_mfma_f32_32x32x16_bf16 v[112:127], v[68:71], a[116:119], v[112:127]
s_mul_i32 s34, s82, 24576
s_add_u32 s34, s34, 73728
v_add_u32 v2, s34, v8
s_mul_i32 s35, s83, 6144
s_add_u32 s34, s34, s35
v_add_u32 v3, s34, v8
s_nop 7
s_cmp_eq_u32 s83, 0
s_cbranch_scc0 Lq_28
ds_write_b128 v2, v[104:107] offset:10240
ds_write_b128 v2, v[108:111] offset:11264
ds_write_b128 v2, v[112:115] offset:14336
ds_write_b128 v2, v[116:119] offset:15360
ds_write_b128 v2, v[120:123] offset:18432
ds_write_b128 v2, v[124:127] offset:19456
v_pk_mov_b32 v[32:33], v[96:97], v[96:97] op_sel:[0,1]
v_pk_mov_b32 v[34:35], v[98:99], v[98:99] op_sel:[0,1]
v_pk_mov_b32 v[36:37], v[100:101], v[100:101] op_sel:[0,1]
v_pk_mov_b32 v[38:39], v[102:103], v[102:103] op_sel:[0,1]
s_branch Lq_31
Lq_28:
s_cmp_eq_u32 s83, 1
s_cbranch_scc0 Lq_29
ds_write_b128 v2, v[96:99] offset:0
ds_write_b128 v2, v[100:103] offset:1024
ds_write_b128 v2, v[112:115] offset:16384
ds_write_b128 v2, v[116:119] offset:17408
ds_write_b128 v2, v[120:123] offset:20480
ds_write_b128 v2, v[124:127] offset:21504
v_pk_mov_b32 v[32:33], v[104:105], v[104:105] op_sel:[0,1]
v_pk_mov_b32 v[34:35], v[106:107], v[106:107] op_sel:[0,1]
v_pk_mov_b32 v[36:37], v[108:109], v[108:109] op_sel:[0,1]
v_pk_mov_b32 v[38:39], v[110:111], v[110:111] op_sel:[0,1]
s_branch Lq_31
Lq_29:
s_cmp_eq_u32 s83, 2
s_cbranch_scc0 Lq_30
ds_write_b128 v2, v[96:99] offset:2048
ds_write_b128 v2, v[100:103] offset:3072
ds_write_b128 v2, v[104:107] offset:6144
ds_write_b128 v2, v[108:111] offset:7168
ds_write_b128 v2, v[120:123] offset:22528
ds_write_b128 v2, v[124:127] offset:23552
v_pk_mov_b32 v[32:33], v[112:113], v[112:113] op_sel:[0,1]
v_pk_mov_b32 v[34:35], v[114:115], v[114:115] op_sel:[0,1]
v_pk_mov_b32 v[36:37], v[116:117], v[116:117] op_sel:[0,1]
v_pk_mov_b32 v[38:39], v[118:119], v[118:119] op_sel:[0,1]
s_branch Lq_31
Lq_30:
ds_write_b128 v2, v[96:99] offset:4096
ds_write_b128 v2, v[100:103] offset:5120
ds_write_b128 v2, v[104:107] offset:8192
ds_write_b128 v2, v[108:111] offset:9216
ds_write_b128 v2, v[112:115] offset:12288
ds_write_b128 v2, v[116:119] offset:13312
v_pk_mov_b32 v[32:33], v[120:121], v[120:121] op_sel:[0,1]
v_pk_mov_b32 v[34:35], v[122:123], v[122:123] op_sel:[0,1]
v_pk_mov_b32 v[36:37], v[124:125], v[124:125] op_sel:[0,1]
v_pk_mov_b32 v[38:39], v[126:127], v[126:127] op_sel:[0,1]
Lq_31:
s_waitcnt lgkmcnt(0)
s_barrier
ds_read_b128 v[40:43], v3 offset:0
ds_read_b128 v[44:47], v3 offset:1024
ds_read_b128 v[48:51], v3 offset:2048
ds_read_b128 v[52:55], v3 offset:3072
ds_read_b128 v[56:59], v3 offset:4096
ds_read_b128 v[60:63], v3 offset:5120
s_waitcnt vmcnt(0)
s_waitcnt lgkmcnt(0)
v_pk_add_f32 v[32:33], v[32:33], v[40:41]
v_pk_add_f32 v[34:35], v[34:35], v[42:43]
v_pk_add_f32 v[36:37], v[36:37], v[44:45]
v_pk_add_f32 v[38:39], v[38:39], v[46:47]
v_pk_add_f32 v[32:33], v[32:33], v[48:49]
v_pk_add_f32 v[34:35], v[34:35], v[50:51]
v_pk_add_f32 v[36:37], v[36:37], v[52:53]
v_pk_add_f32 v[38:39], v[38:39], v[54:55]
v_pk_add_f32 v[32:33], v[32:33], v[56:57]
v_pk_add_f32 v[34:35], v[34:35], v[58:59]
v_pk_add_f32 v[36:37], v[36:37], v[60:61]
v_pk_add_f32 v[38:39], v[38:39], v[62:63]
v_lshlrev_b32 v2, 16, v24
v_and_b32 v3, 0xffff0000, v24
v_add_f32 v32, v32, v2
v_add_f32 v33, v33, v3
v_lshlrev_b32 v2, 16, v25
v_and_b32 v3, 0xffff0000, v25
v_add_f32 v34, v34, v2
v_add_f32 v35, v35, v3
v_lshlrev_b32 v2, 16, v26
v_and_b32 v3, 0xffff0000, v26
v_add_f32 v36, v36, v2
v_add_f32 v37, v37, v3
v_lshlrev_b32 v2, 16, v27
v_and_b32 v3, 0xffff0000, v27
v_add_f32 v38, v38, v2
v_add_f32 v39, v39, v3
v_cvt_pk_bf16_f32 v40, v32, v33
v_cvt_pk_bf16_f32 v41, v34, v35
v_cvt_pk_bf16_f32 v42, v36, v37
v_cvt_pk_bf16_f32 v43, v38, v39
buffer_store_dwordx2 v[40:41], v22, s[92:95], s37 offen offset:0
buffer_store_dwordx2 v[42:43], v22, s[92:95], s37 offen offset:16
parallel_sum__sliding_block__dense_activation_relu__prompt_kernel_end:
s_endpgm
Ln_1_stub:
s_mov_b32 s58, 0
Ln_1_loop:
s_sleep 2
buffer_load_dword v74, v75, s[88:91], 0 offen sc0 sc1
s_waitcnt vmcnt(0)
v_readfirstlane_b32 s23, v74
s_add_u32 s58, s58, 1
s_cmp_gt_u32 s58, 0x10000
s_cbranch_scc1 Ln_1
s_cmp_eq_u32 s23, 0
s_cbranch_scc1 Ln_1_loop
s_branch Ln_1
Lp_5_stub:
s_mov_b32 s58, 0
Lp_5_loop:
s_sleep 3
buffer_load_dword v65, v64, s[16:19], s50 offen sc1
s_waitcnt vmcnt(0)
v_cmp_ne_u32 vcc, s23, v65
s_add_u32 s58, s58, 1
s_cmp_gt_u32 s58, 0x10000
s_cbranch_scc1 Lp_5
s_and_b64 s[56:57], vcc, s[54:55]
s_cbranch_scc1 Lp_5_loop
s_branch Lp_5
Ln_6_stub:
s_mov_b32 s58, 0
Ln_6_loop:
s_sleep 2
buffer_load_dword v6, v7, s[88:91], 0 offen sc0 sc1
s_waitcnt vmcnt(0)
v_readfirstlane_b32 s23, v6
s_add_u32 s58, s58, 1
s_cmp_gt_u32 s58, 0x10000
s_cbranch_scc1 Ln_6
s_cmp_eq_u32 s23, 0
s_cbranch_scc1 Ln_6_loop
s_branch Ln_6
Lp_7_stub:
s_mov_b32 s58, 0
Lp_7_loop:
s_sleep 3
buffer_load_dwordx2 v[120:121], v25, s[16:19], s50 offen sc1
s_waitcnt vmcnt(0)
v_cmp_ne_u32 vcc, s23, v121
s_add_u32 s58, s58, 1
s_cmp_gt_u32 s58, 0x10000
s_cbranch_scc1 Lp_7
s_and_b64 s[56:57], vcc, exec
s_cbranch_scc1 Lp_7_loop
s_branch Lp_7
Lt_9_stub:
s_nop 7
v_mov_b32 v48, 0
v_mov_b32 v49, 0
v_mov_b32 v50, 0
v_mov_b32 v51, 0
v_mov_b32 v52, 0
v_mov_b32 v53, 0
v_mov_b32 v54, 0
v_mov_b32 v55, 0
v_mov_b32 v56, 0
v_mov_b32 v57, 0
v_mov_b32 v58, 0
v_mov_b32 v59, 0
v_mov_b32 v60, 0
v_mov_b32 v61, 0
v_mov_b32 v62, 0
v_mov_b32 v63, 0
s_nop 1
s_branch Lt_9
Lt_10_stub:
s_nop 7
v_mov_b32 v48, 0
v_mov_b32 v49, 0
v_mov_b32 v50, 0
v_mov_b32 v51, 0
v_mov_b32 v52, 0
v_mov_b32 v53, 0
v_mov_b32 v54, 0
v_mov_b32 v55, 0
v_mov_b32 v56, 0
v_mov_b32 v57, 0
v_mov_b32 v58, 0
v_mov_b32 v59, 0
v_mov_b32 v60, 0
v_mov_b32 v61, 0
v_mov_b32 v62, 0
v_mov_b32 v63, 0
s_nop 1
s_branch Lt_10
Lt_11_stub:
s_nop 7
v_mov_b32 v48, 0
v_mov_b32 v49, 0
v_mov_b32 v50, 0
v_mov_b32 v51, 0
v_mov_b32 v52, 0
v_mov_b32 v53, 0
v_mov_b32 v54, 0
v_mov_b32 v55, 0
v_mov_b32 v56, 0
v_mov_b32 v57, 0
v_mov_b32 v58, 0
v_mov_b32 v59, 0
v_mov_b32 v60, 0
v_mov_b32 v61, 0
v_mov_b32 v62, 0
v_mov_b32 v63, 0
s_nop 1
s_branch Lt_11
Lt_12_stub:
s_nop 7
v_mov_b32 v48, 0
v_mov_b32 v49, 0
v_mov_b32 v50, 0
v_mov_b32 v51, 0
v_mov_b32 v52, 0
v_mov_b32 v53, 0
v_mov_b32 v54, 0
v_mov_b32 v55, 0
v_mov_b32 v56, 0
v_mov_b32 v57, 0
v_mov_b32 v58, 0
v_mov_b32 v59, 0
v_mov_b32 v60, 0
v_mov_b32 v61, 0
v_mov_b32 v62, 0
v_mov_b32 v63, 0
s_nop 1
s_branch Lt_12
Lt_13_stub:
s_nop 7
v_mov_b32 v48, 0
v_mov_b32 v49, 0
v_mov_b32 v50, 0
v_mov_b32 v51, 0
v_mov_b32 v52, 0
v_mov_b32 v53, 0
v_mov_b32 v54, 0
v_mov_b32 v55, 0
v_mov_b32 v56, 0
v_mov_b32 v57, 0
v_mov_b32 v58, 0
v_mov_b32 v59, 0
v_mov_b32 v60, 0
v_mov_b32 v61, 0
v_mov_b32 v62, 0
v_mov_b32 v63, 0
s_nop 1
s_branch Lt_13
Lt_14_stub:
s_nop 7
v_mov_b32 v48, 0
v_mov_b32 v49, 0
v_mov_b32 v50, 0
v_mov_b32 v51, 0
v_mov_b32 v52, 0
v_mov_b32 v53, 0
v_mov_b32 v54, 0
v_mov_b32 v55, 0
v_mov_b32 v56, 0
v_mov_b32 v57, 0
v_mov_b32 v58, 0
v_mov_b32 v59, 0
v_mov_b32 v60, 0
v_mov_b32 v61, 0
v_mov_b32 v62, 0
v_mov_b32 v63, 0
s_nop 1
s_branch Lt_14
Lt_15_stub:
s_nop 7
v_mov_b32 v48, 0
v_mov_b32 v49, 0
v_mov_b32 v50, 0
v_mov_b32 v51, 0
v_mov_b32 v52, 0
v_mov_b32 v53, 0
v_mov_b32 v54, 0
v_mov_b32 v55, 0
v_mov_b32 v56, 0
v_mov_b32 v57, 0
v_mov_b32 v58, 0
v_mov_b32 v59, 0
v_mov_b32 v60, 0
v_mov_b32 v61, 0
v_mov_b32 v62, 0
v_mov_b32 v63, 0
s_nop 1
s_branch Lt_15
Lt_16_stub:
s_nop 7
v_mov_b32 v48, 0
v_mov_b32 v49, 0
v_mov_b32 v50, 0
v_mov_b32 v51, 0
v_mov_b32 v52, 0
v_mov_b32 v53, 0
v_mov_b32 v54, 0
v_mov_b32 v55, 0
v_mov_b32 v56, 0
v_mov_b32 v57, 0
v_mov_b32 v58, 0
v_mov_b32 v59, 0
v_mov_b32 v60, 0
v_mov_b32 v61, 0
v_mov_b32 v62, 0
v_mov_b32 v63, 0
s_nop 1
s_branch Lt_16
Lt_17_stub:
s_nop 7
v_mov_b32 v48, v12
v_mov_b32 v49, v12
v_mov_b32 v50, v12
v_mov_b32 v51, v12
v_mov_b32 v52, v12
v_mov_b32 v53, v12
v_mov_b32 v54, v12
v_mov_b32 v55, v12
v_mov_b32 v56, v12
v_mov_b32 v57, v12
v_mov_b32 v58, v12
v_mov_b32 v59, v12
v_mov_b32 v60, v12
v_mov_b32 v61, v12
v_mov_b32 v62, v12
v_mov_b32 v63, v12
s_nop 1
s_branch Lt_17
Lt_18_stub:
s_nop 7
v_mov_b32 v48, v12
v_mov_b32 v49, v12
v_mov_b32 v50, v12
v_mov_b32 v51, v12
v_mov_b32 v52, v12
v_mov_b32 v53, v12
v_mov_b32 v54, v12
v_mov_b32 v55, v12
v_mov_b32 v56, v12
v_mov_b32 v57, v12
v_mov_b32 v58, v12
v_mov_b32 v59, v12
v_mov_b32 v60, v12
v_mov_b32 v61, v12
v_mov_b32 v62, v12
v_mov_b32 v63, v12
s_nop 1
s_branch Lt_18
Lt_19_stub:
s_nop 7
v_mov_b32 v48, v12
v_mov_b32 v49, v12
v_mov_b32 v50, v12
v_mov_b32 v51, v12
v_mov_b32 v52, v12
v_mov_b32 v53, v12
v_mov_b32 v54, v12
v_mov_b32 v55, v12
v_mov_b32 v56, v12
v_mov_b32 v57, v12
v_mov_b32 v58, v12
v_mov_b32 v59, v12
v_mov_b32 v60, v12
v_mov_b32 v61, v12
v_mov_b32 v62, v12
v_mov_b32 v63, v12
s_nop 1
s_branch Lt_19
Lt_20_stub:
s_nop 7
v_mov_b32 v48, v12
v_mov_b32 v49, v12
v_mov_b32 v50, v12
v_mov_b32 v51, v12
v_mov_b32 v52, v12
v_mov_b32 v53, v12
v_mov_b32 v54, v12
v_mov_b32 v55, v12
v_mov_b32 v56, v12
v_mov_b32 v57, v12
v_mov_b32 v58, v12
v_mov_b32 v59, v12
v_mov_b32 v60, v12
v_mov_b32 v61, v12
v_mov_b32 v62, v12
v_mov_b32 v63, v12
s_nop 1
s_branch Lt_20
Lp_21_stub:
s_mov_b32 s58, 0
Lp_21_loop:
s_sleep 3
buffer_load_dword v3, v5, s[16:19], s89 offen sc1
s_waitcnt vmcnt(0)
v_cmp_ne_u32 vcc, s23, v3
s_add_u32 s58, s58, 1
s_cmp_gt_u32 s58, 0x10000
s_cbranch_scc1 Lp_21
s_and_b64 s[56:57], vcc, exec
s_cbranch_scc1 Lp_21_loop
s_branch Lp_21
Lt_22_stub:
s_nop 7
v_mov_b32 v48, v12
v_mov_b32 v49, v12
v_mov_b32 v50, v12
v_mov_b32 v51, v12
v_mov_b32 v52, v12
v_mov_b32 v53, v12
v_mov_b32 v54, v12
v_mov_b32 v55, v12
v_mov_b32 v56, v12
v_mov_b32 v57, v12
v_mov_b32 v58, v12
v_mov_b32 v59, v12
v_mov_b32 v60, v12
v_mov_b32 v61, v12
v_mov_b32 v62, v12
v_mov_b32 v63, v12
s_nop 1
s_branch Lt_22
Lt_23_stub:
s_nop 7
v_mov_b32 v48, v12
v_mov_b32 v49, v12
v_mov_b32 v50, v12
v_mov_b32 v51, v12
v_mov_b32 v52, v12
v_mov_b32 v53, v12
v_mov_b32 v54, v12
v_mov_b32 v55, v12
v_mov_b32 v56, v12
v_mov_b32 v57, v12
v_mov_b32 v58, v12
v_mov_b32 v59, v12
v_mov_b32 v60, v12
v_mov_b32 v61, v12
v_mov_b32 v62, v12
v_mov_b32 v63, v12
s_nop 1
s_branch Lt_23
Lt_24_stub:
s_nop 7
v_mov_b32 v48, v12
v_mov_b32 v49, v12
v_mov_b32 v50, v12
v_mov_b32 v51, v12
v_mov_b32 v52, v12
v_mov_b32 v53, v12
v_mov_b32 v54, v12
v_mov_b32 v55, v12
v_mov_b32 v56, v12
v_mov_b32 v57, v12
v_mov_b32 v58, v12
v_mov_b32 v59, v12
v_mov_b32 v60, v12
v_mov_b32 v61, v12
v_mov_b32 v62, v12
v_mov_b32 v63, v12
s_nop 1
s_branch Lt_24
Lt_25_stub:
s_nop 7
v_mov_b32 v48, v12
v_mov_b32 v49, v12
v_mov_b32 v50, v12
v_mov_b32 v51, v12
v_mov_b32 v52, v12
v_mov_b32 v53, v12
v_mov_b32 v54, v12
v_mov_b32 v55, v12
v_mov_b32 v56, v12
v_mov_b32 v57, v12
v_mov_b32 v58, v12
v_mov_b32 v59, v12
v_mov_b32 v60, v12
v_mov_b32 v61, v12
v_mov_b32 v62, v12
v_mov_b32 v63, v12
s_nop 1
s_branch Lt_25
Lp_26_stub:
s_mov_b32 s58, 0
Lp_26_loop:
s_sleep 3
buffer_load_dword v3, v5, s[16:19], s89 offen sc1
s_waitcnt vmcnt(0)
v_cmp_ne_u32 vcc, s23, v3
s_add_u32 s58, s58, 1
s_cmp_gt_u32 s58, 0x10000
s_cbranch_scc1 Lp_26
s_and_b64 s[56:57], vcc, exec
s_cbranch_scc1 Lp_26_loop
s_branch Lp_26
Lcode_end:
.section .rodata,"a"
.p2align 6
.amdhsa_kernel parallel_sum__sliding_block__dense_activation_relu__prompt_kernel
  .amdhsa_next_free_vgpr 256
  .amdhsa_next_free_sgpr 102
  .amdhsa_accum_offset 128
  .amdhsa_group_segment_fixed_size 0
  .amdhsa_kernarg_size 72
  .amdhsa_user_sgpr_count 2
  .amdhsa_user_sgpr_kernarg_segment_ptr 1
  .amdhsa_system_sgpr_workgroup_id_x 1
  .amdhsa_float_denorm_mode_32 3
.end_amdhsa_kernel
```
